```python
import torch

def _softmax(x, axis=-1):
    return torch.softmax(x, dim=axis)
def _gelu(x):
    return torch.nn.functional.gelu(x, approximate="tanh")
def _silu(x):
    return torch.nn.functional.silu(x)
def _sigmoid(x):
    return torch.sigmoid(x)
def _layernorm(x, axis=-1, eps=1e-5):
    m = x.mean(dim=axis, keepdim=True)
    v = x.var(dim=axis, keepdim=True, unbiased=False)
    return (x - m) / torch.sqrt(v + eps)
def _scatter_add(tgt, idx, src, axis=0):
    return tgt.clone().index_add_(axis, idx, src)
def _segment_sum(src, seg, n):
    out = torch.zeros((n,) + src.shape[1:], dtype=src.dtype)
    return out.index_add_(0, seg, src)
def _pad(x, pw):
    flat = tuple(v for pair in reversed(pw) for v in pair)
    return torch.nn.functional.pad(x, flat)

kernel_name = 'sequential_preLN__grouped_kv_mqa__geglu_ffn__prompt'

def setup_inputs():

    _w = (lambda a: (lambda t: t.to(torch.bfloat16) if t.is_floating_point() else t)(torch.as_tensor(a)))
    def _A_setup():
        B, S, D, H = 1, 2048, 640, 32
        Dh = D // H
        return {
            "x": _w((lambda *s: torch.randn(*s, dtype=torch.bfloat16) * 0.05)(B, S, D)),
            "wq": _w((lambda *s: torch.randn(*s, dtype=torch.bfloat16) * 0.05)(D, H * Dh)),
            "wk": _w((lambda *s: torch.randn(*s, dtype=torch.bfloat16) * 0.05)(D, Dh)),
            "wv": _w((lambda *s: torch.randn(*s, dtype=torch.bfloat16) * 0.05)(D, Dh)),
            "wo": _w((lambda *s: torch.randn(*s, dtype=torch.bfloat16) * 0.05)(H * Dh, D)),
        }
    _A_in = _A_setup()

    def _B_setup():
        B, S, D, F = 1, 2048, 640, 1536
        return {
            "x": _w((lambda *s: torch.randn(*s, dtype=torch.bfloat16) * 0.05)(B, S, D)),
            "w_gate": _w((lambda *s: torch.randn(*s, dtype=torch.bfloat16) * 0.05)(D, F)),
            "w_up": _w((lambda *s: torch.randn(*s, dtype=torch.bfloat16) * 0.05)(D, F)),
            "w_down": _w((lambda *s: torch.randn(*s, dtype=torch.bfloat16) * 0.05)(F, D)),
        }
    _B_in = _B_setup()

    return {
        "A_x": _A_in["x"],
        "A_wq": _A_in["wq"],
        "A_wk": _A_in["wk"],
        "A_wv": _A_in["wv"],
        "A_wo": _A_in["wo"],
        "B_x": _B_in["x"],
        "B_w_gate": _B_in["w_gate"],
        "B_w_up": _B_in["w_up"],
        "B_w_down": _B_in["w_down"],
    }

def reference(A_x, A_wq, A_wk, A_wv, A_wo, B_x, B_w_gate, B_w_up, B_w_down):
    def _A_ref(x, wq, wk, wv, wo):
        B, S, D = x.shape
        H = 32
        Dh = D // H
        q = (lambda x, *d: x.permute(*d))((x @ wq).reshape(B, S, H, Dh), 0, 2, 1, 3)
        k = x @ wk
        v = x @ wv
        scores = torch.einsum("bhqd,bkd->bhqk", q, k) * (Dh ** -0.5)
        p = _softmax(scores, axis=-1)
        o = torch.einsum("bhqk,bkd->bhqd", p, v)
        return (lambda x, *d: x.permute(*d))(o, 0, 2, 1, 3).reshape(B, S, H * Dh) @ wo

    def _B_ref(x, w_gate, w_up, w_down):
        return (_gelu(x @ w_gate) * (x @ w_up)) @ w_down

    x = A_x
    h = x + _A_ref(_layernorm(x, axis=-1), A_wq, A_wk, A_wv, A_wo)
    h2 = h + _B_ref(_layernorm(h, axis=-1), B_w_gate, B_w_up, B_w_down)
    return h2
```

```asm
; @launch kernel=k2_attn_kernel grid=(256,1,1) block=(512,1,1) lds=163840
.amdgcn_target "amdgcn-amd-amdhsa--gfx950"
.text
.globl k2_attn_kernel
.p2align 8
.type k2_attn_kernel,@function
k2_attn_kernel:
    s_cmp_ge_u32 s2, 256
    s_cbranch_scc1 k2_end
    s_load_dwordx16 s[16:31], s[0:1], 0
    s_load_dwordx8 s[32:39], s[0:1], 64
    s_and_b32 s13, s2, 7
    s_lshr_b32 s12, s2, 3
    s_lshr_b32 s72, s12, 3
    s_lshl_b32 s71, s13, 2
    s_add_u32 s71, s71, s72
    s_lshl_b32 s68, s71, 6
    s_and_b32 s70, s12, 7
    s_mul_i32 s69, s70, 160
    v_lshrrev_b32 v1, 6, v0
    v_and_b32 v11, 63, v0
    v_readfirstlane_b32 s67, v1
    v_lshlrev_b32 v10, 4, v11
    v_and_b32 v12, 31, v0
    v_bfe_u32 v13, v0, 5, 1
    s_waitcnt lgkmcnt(0)
    s_cmp_lt_u32 s67, 4
    s_cbranch_scc1 k2_comp
    v_and_b32 v0, 255, v0
    s_mov_b32 s40, s16
    s_mov_b32 s41, s17
    s_mov_b32 s42, 2621440
    s_mov_b32 s43, 0x00020000
    s_bitcmp0_b32 s12, 2
    s_cselect_b32 s52, s20, s22
    s_cselect_b32 s53, s21, s23
    s_mov_b32 s54, 25600
    s_mov_b32 s55, 0x00020000
    s_and_b32 s71, s12, 3
    s_lshl_b32 s71, s71, 4
    s_add_u32 s71, s71, s68
    v_and_b32 v30, 15, v0
    v_add_u32 v30, s71, v30
    v_mul_u32_u24 v30, 1280, v30
    v_and_b32 v31, 0xf0, v0
    v_add_u32 v30, v30, v31
    v_lshlrev_b32 v31, 4, v0
    s_and_b32 s64, s67, 3
    s_lshl_b32 s64, s64, 10
    s_add_u32 m0, s64, 0
    s_mov_b32 s71, 0
    buffer_load_dwordx4 v30, s[40:43], s71 offen lds
    s_add_u32 m0, s64, 20480
    s_mov_b32 s71, 0
    buffer_load_dwordx4 v31, s[52:55], s71 offen lds
    s_add_u32 m0, s64, 4096
    s_mov_b32 s71, 256
    buffer_load_dwordx4 v30, s[40:43], s71 offen lds
    s_add_u32 m0, s64, 24576
    s_mov_b32 s71, 4096
    buffer_load_dwordx4 v31, s[52:55], s71 offen lds
    s_add_u32 m0, s64, 8192
    s_mov_b32 s71, 512
    buffer_load_dwordx4 v30, s[40:43], s71 offen lds
    s_add_u32 m0, s64, 28672
    s_mov_b32 s71, 8192
    buffer_load_dwordx4 v31, s[52:55], s71 offen lds
    s_add_u32 m0, s64, 12288
    s_mov_b32 s71, 768
    buffer_load_dwordx4 v30, s[40:43], s71 offen lds
    s_add_u32 m0, s64, 32768
    s_mov_b32 s71, 12288
    buffer_load_dwordx4 v31, s[52:55], s71 offen lds
    s_add_u32 m0, s64, 16384
    s_mov_b32 s71, 1024
    buffer_load_dwordx4 v30, s[40:43], s71 offen lds
    s_add_u32 m0, s64, 36864
    s_mov_b32 s71, 16384
    buffer_load_dwordx4 v31, s[52:55], s71 offen lds
    s_add_u32 m0, s64, 40960
    s_mov_b32 s71, 20480
    buffer_load_dwordx4 v31, s[52:55], s71 offen lds
    s_add_u32 m0, s64, 45056
    s_mov_b32 s71, 24576
    buffer_load_dwordx4 v31, s[52:55], s71 offen lds
    s_add_u32 s8, s38, 14684160
    s_addc_u32 s9, s39, 0
    s_mov_b32 s10, 32768
    s_mov_b32 s11, 0x00020000
    s_branch k2_helper
k2_comp:
    s_add_u32 s8, s38, 14684160
    s_addc_u32 s9, s39, 0
    s_mov_b32 s10, 32768
    s_mov_b32 s11, 0x00020000
    s_add_u32 s44, s38, 2621440
    s_addc_u32 s45, s39, 0
    s_mov_b32 s46, 163840
    s_mov_b32 s47, 0x00020000
    s_add_u32 s56, s38, 3018752
    s_addc_u32 s57, s39, 0
    s_mov_b32 s58, 2621440
    s_mov_b32 s59, 0x00020000
    s_mov_b32 s48, s16
    s_mov_b32 s49, s17
    s_mov_b32 s50, 2621440
    s_mov_b32 s51, 0x00020000
    v_mov_b32 v19, 0
    v_mov_b32 v20, 0
    v_mov_b32 v21, 0
    v_mov_b32 v16, 0
    v_mov_b32 v17, 0
    v_mov_b32 v18, 0
    s_mov_b32 s60, s36
    s_mov_b32 s61, s37
    s_mov_b32 s62, 256
    s_mov_b32 s63, 0x00020000
    s_add_u32 s52, s38, 2883584
    s_addc_u32 s53, s39, 0
    s_mov_b32 s54, 512
    s_mov_b32 s55, 0x00020000
    v_mov_b32 v72, 0
    v_mov_b32 v73, 1
    s_lshl_b32 s71, s2, 2
    s_add_u32 s71, s71, s67
    s_cmp_lg_u32 s71, 3
    s_cbranch_scc1 bz_1
    v_and_b32 v1, 63, v0
    v_lshlrev_b32 v1, 8, v1
    v_mov_b32 v28, 0
    v_mov_b32 v29, 0
    v_mov_b32 v30, 0
    v_mov_b32 v31, 0
    s_mov_b32 s72, 16384
    buffer_store_dwordx4 v[28:31], v1, s[8:11], 0 offen sc1
    buffer_store_dwordx4 v[28:31], v1, s[8:11], 0 offen offset:128 sc1
    buffer_store_dwordx4 v[28:31], v1, s[8:11], s72 offen sc1
    s_mov_b64 exec, 1
    s_waitcnt vmcnt(0)
    buffer_store_dword v73, v72, s[60:63], 0 offen offset:128 sc1
    s_mov_b64 exec, -1
bz_1:
    v_and_b32 v83, 63, v0
    v_lshrrev_b32 v86, 6, v0
    v_and_b32 v84, 15, v0
    v_bfe_u32 v85, v0, 4, 2
    v_and_b32 v87, 1, v86
    v_lshrrev_b32 v88, 1, v86
    v_lshrrev_b32 v1, 1, v85
    v_lshlrev_b32 v1, 4, v1
    v_and_b32 v2, 1, v85
    v_lshl_add_u32 v1, v2, 2, v1
    v_lshrrev_b32 v2, 2, v84
    v_add_u32 v1, v1, v2
    v_mov_b32 v2, 64
    v_mad_u32_u24 v1, v88, v2, v1
    v_mul_u32_u24 v1, 160, v1
    v_and_b32 v2, 3, v84
    v_lshl_add_u32 v1, v2, 3, v1
    v_mov_b32 v89, v1
    v_mul_u32_u24 v1, 32, v87
    v_add_u32 v1, v1, v84
    v_and_b32 v2, 15, v1
    v_mul_u32_u24 v1, 256, v1
    v_mul_u32_u24 v3, 8, v88
    v_add3_u32 v3, v3, v85, 0
    v_xor_b32 v3, v3, v2
    v_lshl_add_u32 v90, v3, 4, v1
    v_mul_u32_u24 v3, 8, v88
    v_add3_u32 v3, v3, v85, 4
    v_xor_b32 v3, v3, v2
    v_lshl_add_u32 v91, v3, 4, v1
    v_mul_u32_u24 v3, 4096, v88
    v_sub_u32 v4, 4096, v3
    v_add_u32 v92, v4, v90
    v_add_u32 v90, v3, v90
    v_add_u32 v93, v4, v91
    v_add_u32 v91, v3, v91
    v_add_u32 v89, 53248, v89
    v_add_u32 v90, 53248, v90
    v_add_u32 v91, 53248, v91
    v_add_u32 v92, 53248, v92
    v_add_u32 v93, 53248, v93
    v_mov_b32 v192, 0x3f803f80
    v_mov_b32 v193, 0x3f803f80
    v_mov_b32 v194, 0x3f803f80
    v_mov_b32 v195, 0x3f803f80
    v_mov_b32 v152, 0
    v_mov_b32 v153, 0
    v_mov_b32 v154, 0
    v_mov_b32 v155, 0
    v_mov_b32 v156, 0
    v_mov_b32 v157, 0
    v_mov_b32 v158, 0
    v_mov_b32 v159, 0
    v_mov_b32 v160, 0
    v_mov_b32 v161, 0
    v_mov_b32 v162, 0
    v_mov_b32 v163, 0
    v_mov_b32 v164, 0
    v_mov_b32 v165, 0
    v_mov_b32 v166, 0
    v_mov_b32 v167, 0
    v_mov_b32 v168, 0
    v_mov_b32 v169, 0
    v_mov_b32 v170, 0
    v_mov_b32 v171, 0
    v_mov_b32 v172, 0
    v_mov_b32 v173, 0
    v_mov_b32 v174, 0
    v_mov_b32 v175, 0
    v_mov_b32 v176, 0
    v_mov_b32 v177, 0
    v_mov_b32 v178, 0
    v_mov_b32 v179, 0
    v_mov_b32 v180, 0
    v_mov_b32 v181, 0
    v_mov_b32 v182, 0
    v_mov_b32 v183, 0
    v_mov_b32 v184, 0
    v_mov_b32 v185, 0
    v_mov_b32 v186, 0
    v_mov_b32 v187, 0
    v_mov_b32 v188, 0
    v_mov_b32 v189, 0
    v_mov_b32 v190, 0
    v_mov_b32 v191, 0
    v_mov_b32 v196, 0
    v_mov_b32 v197, 0
    v_mov_b32 v198, 0
    v_mov_b32 v199, 0
    v_mov_b32 v200, 0
    v_mov_b32 v201, 0
    v_mov_b32 v202, 0
    v_mov_b32 v203, 0
    v_mov_b32 v204, 0
    v_mov_b32 v205, 0
    v_mov_b32 v206, 0
    v_mov_b32 v207, 0
    v_mov_b32 v208, 0
    v_mov_b32 v209, 0
    v_mov_b32 v210, 0
    v_mov_b32 v211, 0
    v_mov_b32 v212, 0
    v_mov_b32 v213, 0
    v_mov_b32 v214, 0
    v_mov_b32 v215, 0
    v_mov_b32 v216, 0
    v_mov_b32 v217, 0
    v_mov_b32 v218, 0
    v_mov_b32 v219, 0
    v_mov_b32 v220, 0
    v_mov_b32 v221, 0
    v_mov_b32 v222, 0
    v_mov_b32 v223, 0
    v_mov_b32 v224, 0
    v_mov_b32 v225, 0
    v_mov_b32 v226, 0
    v_mov_b32 v227, 0
    v_mov_b32 v228, 0
    v_mov_b32 v229, 0
    v_mov_b32 v230, 0
    v_mov_b32 v231, 0
    s_cmp_eq_u32 s67, 0
    s_cselect_b32 s15, 2, 0
    s_and_b32 s7, s2, 15
    s_lshl_b32 s7, s7, 8
    s_add_u32 s7, s7, 24576
    v_lshlrev_b32 v74, 8, v83
    v_mul_u32_u24 v1, 5120, v86
    v_lshl_add_u32 v68, v83, 4, v1
    v_mul_u32_u24 v1, 6400, v86
    v_add_u32 v1, 20480, v1
    v_lshl_add_u32 v70, v83, 4, v1
    v_lshrrev_b32 v2, 2, v84
    v_lshl_add_u32 v2, v85, 3, v2
    v_mad_u32_u24 v1, v2, 40, v1
    v_and_b32 v2, 3, v84
    v_lshl_add_u32 v69, v2, 3, v1
    v_mul_u32_u24 v1, 8192, v86
    v_lshl_add_u32 v1, v83, 4, v1
    v_add_u32 v79, 53248, v1
    v_xor_b32 v80, 16384, v1
    v_add_u32 v80, 53248, v80
    v_lshlrev_b32 v1, 4, v84
    v_sub_u32 v81, v80, v1
    v_lshl_add_u32 v2, v87, 1, v88
    v_lshl_add_u32 v2, v2, 4, v84
    v_mul_u32_u24 v3, 160, v2
    v_lshl_add_u32 v3, v85, 3, v3
    v_add_u32 v82, 102400, v3
    v_add_u32 v3, s68, v2
    v_mul_u32_u24 v3, 1280, v3
    v_lshl_add_u32 v3, v85, 3, v3
    v_add_u32 v254, s69, v3
    ds_write_b32 v72, v72 offset:50176
    s_waitcnt lgkmcnt(0)
    s_barrier
    buffer_load_dword v71, v72, s[60:63], 0 offen offset:128 sc1
    ds_read_b128 v[28:31], v68 offset:0
    ds_read_b64_tr_b16 v[32:33], v69 offset:0
    ds_read_b64_tr_b16 v[34:35], v69 offset:160
    ds_read_b64_tr_b16 v[36:37], v69 offset:32
    ds_read_b64_tr_b16 v[38:39], v69 offset:192
    ds_read_b128 v[40:43], v68 offset:1024
    ds_read_b64_tr_b16 v[96:97], v69 offset:1280
    ds_read_b64_tr_b16 v[98:99], v69 offset:1440
    ds_read_b64_tr_b16 v[100:101], v69 offset:1312
    ds_read_b64_tr_b16 v[102:103], v69 offset:1472
    ds_read_b128 v[104:107], v68 offset:2048
    ds_read_b64_tr_b16 v[108:109], v69 offset:2560
    ds_read_b64_tr_b16 v[110:111], v69 offset:2720
    ds_read_b64_tr_b16 v[112:113], v69 offset:2592
    ds_read_b64_tr_b16 v[114:115], v69 offset:2752
    ds_read_b128 v[116:119], v68 offset:3072
    ds_read_b64_tr_b16 v[120:121], v69 offset:3840
    ds_read_b64_tr_b16 v[122:123], v69 offset:4000
    ds_read_b64_tr_b16 v[124:125], v69 offset:3872
    ds_read_b64_tr_b16 v[126:127], v69 offset:4032
    ds_read_b128 v[128:131], v68 offset:4096
    ds_read_b64_tr_b16 v[132:133], v69 offset:5120
    ds_read_b64_tr_b16 v[134:135], v69 offset:5280
    ds_read_b64_tr_b16 v[136:137], v69 offset:5152
    ds_read_b64_tr_b16 v[138:139], v69 offset:5312
    s_waitcnt lgkmcnt(15)
    v_mfma_f32_16x16x32_bf16 v[44:47], v[32:35], v[28:31], 0
    v_mfma_f32_16x16x32_bf16 v[48:51], v[36:39], v[28:31], 0
    v_mfma_f32_16x16x32_bf16 v[52:55], v[32:35], v[192:195], 0
    v_mfma_f32_16x16x32_bf16 v[56:59], v[36:39], v[192:195], 0
    v_mfma_f32_16x16x32_bf16 v[60:63], v[192:195], v[28:31], 0
    v_mfma_f32_16x16x32_bf16 v[64:67], v[28:31], v[28:31], 0
    s_waitcnt lgkmcnt(15)
    v_mfma_f32_16x16x32_bf16 v[44:47], v[96:99], v[40:43], v[44:47]
    v_mfma_f32_16x16x32_bf16 v[48:51], v[100:103], v[40:43], v[48:51]
    v_mfma_f32_16x16x32_bf16 v[52:55], v[96:99], v[192:195], v[52:55]
    v_mfma_f32_16x16x32_bf16 v[56:59], v[100:103], v[192:195], v[56:59]
    v_mfma_f32_16x16x32_bf16 v[60:63], v[192:195], v[40:43], v[60:63]
    v_mfma_f32_16x16x32_bf16 v[64:67], v[40:43], v[40:43], v[64:67]
    s_waitcnt lgkmcnt(10)
    v_mfma_f32_16x16x32_bf16 v[44:47], v[108:111], v[104:107], v[44:47]
    v_mfma_f32_16x16x32_bf16 v[48:51], v[112:115], v[104:107], v[48:51]
    v_mfma_f32_16x16x32_bf16 v[52:55], v[108:111], v[192:195], v[52:55]
    v_mfma_f32_16x16x32_bf16 v[56:59], v[112:115], v[192:195], v[56:59]
    v_mfma_f32_16x16x32_bf16 v[60:63], v[192:195], v[104:107], v[60:63]
    v_mfma_f32_16x16x32_bf16 v[64:67], v[104:107], v[104:107], v[64:67]
    s_waitcnt lgkmcnt(5)
    v_mfma_f32_16x16x32_bf16 v[44:47], v[120:123], v[116:119], v[44:47]
    v_mfma_f32_16x16x32_bf16 v[48:51], v[124:127], v[116:119], v[48:51]
    v_mfma_f32_16x16x32_bf16 v[52:55], v[120:123], v[192:195], v[52:55]
    v_mfma_f32_16x16x32_bf16 v[56:59], v[124:127], v[192:195], v[56:59]
    v_mfma_f32_16x16x32_bf16 v[60:63], v[192:195], v[116:119], v[60:63]
    v_mfma_f32_16x16x32_bf16 v[64:67], v[116:119], v[116:119], v[64:67]
    s_waitcnt lgkmcnt(0)
    v_mfma_f32_16x16x32_bf16 v[44:47], v[132:135], v[128:131], v[44:47]
    v_mfma_f32_16x16x32_bf16 v[48:51], v[136:139], v[128:131], v[48:51]
    v_mfma_f32_16x16x32_bf16 v[52:55], v[132:135], v[192:195], v[52:55]
    v_mfma_f32_16x16x32_bf16 v[56:59], v[136:139], v[192:195], v[56:59]
    v_mfma_f32_16x16x32_bf16 v[60:63], v[192:195], v[128:131], v[60:63]
    v_mfma_f32_16x16x32_bf16 v[64:67], v[128:131], v[128:131], v[64:67]
    s_nop 7
    s_nop 7
    s_cmp_eq_u32 s67, 0
    s_cbranch_scc1 pw_2
    ds_write_b128 v70, v[44:47] offset:0
    ds_write_b128 v70, v[48:51] offset:1024
    ds_write_b128 v70, v[52:55] offset:2048
    ds_write_b128 v70, v[56:59] offset:3072
    ds_write_b128 v70, v[60:63] offset:4096
    ds_write_b128 v70, v[64:67] offset:5120
    s_mov_b64 exec, 1
    ds_add_u32 v72, v73 offset:50176
    s_mov_b64 exec, -1
pw_2:
    s_cmp_lg_u32 s67, 0
    s_cbranch_scc1 fz_3
fz_6:
    ds_read_b32 v1, v72 offset:50176
    s_waitcnt lgkmcnt(0)
    v_readfirstlane_b32 s72, v1
    s_nop 3
    s_cmp_lt_u32 s72, 3
    s_cbranch_scc1 fz_6
    ds_read_b128 v[96:99], v70 offset:10496
    ds_read_b128 v[120:123], v70 offset:16896
    ds_read_b128 v[144:147], v70 offset:23296
    ds_read_b128 v[100:103], v70 offset:11520
    ds_read_b128 v[124:127], v70 offset:17920
    ds_read_b128 v[148:151], v70 offset:24320
    ds_read_b128 v[28:31], v70 offset:6400
    ds_read_b128 v[104:107], v70 offset:12800
    ds_read_b128 v[128:131], v70 offset:19200
    ds_read_b128 v[36:39], v70 offset:8448
    ds_read_b128 v[112:115], v70 offset:14848
    ds_read_b128 v[136:139], v70 offset:21248
    ds_read_b128 v[32:35], v70 offset:7424
    ds_read_b128 v[108:111], v70 offset:13824
    ds_read_b128 v[132:135], v70 offset:20224
    ds_read_b128 v[40:43], v70 offset:9472
    ds_read_b128 v[116:119], v70 offset:15872
    ds_read_b128 v[140:143], v70 offset:22272
    s_and_b32 s71, s12, 3
    s_lshl_b32 s71, s71, 4
    s_add_u32 s71, s71, s68
    s_lshr_b32 s65, s71, 2
    s_lshr_b32 s71, s71, 5
    s_mul_i32 s66, s71, 2560
    s_and_b32 s70, s12, 1
    s_waitcnt lgkmcnt(15)
    v_pk_add_f32 v[60:61], v[60:61], v[96:97]
    v_pk_add_f32 v[60:61], v[60:61], v[120:121]
    v_pk_add_f32 v[60:61], v[60:61], v[144:145]
    s_waitcnt lgkmcnt(12)
    v_pk_add_f32 v[64:65], v[64:65], v[100:101]
    v_pk_add_f32 v[66:67], v[66:67], v[102:103]
    v_pk_add_f32 v[64:65], v[64:65], v[124:125]
    v_pk_add_f32 v[66:67], v[66:67], v[126:127]
    v_pk_add_f32 v[64:65], v[64:65], v[148:149]
    v_pk_add_f32 v[66:67], v[66:67], v[150:151]
    s_waitcnt lgkmcnt(9)
    v_pk_add_f32 v[44:45], v[44:45], v[28:29]
    v_pk_add_f32 v[46:47], v[46:47], v[30:31]
    v_pk_add_f32 v[44:45], v[44:45], v[104:105]
    v_pk_add_f32 v[46:47], v[46:47], v[106:107]
    v_pk_add_f32 v[44:45], v[44:45], v[128:129]
    v_pk_add_f32 v[46:47], v[46:47], v[130:131]
    s_waitcnt lgkmcnt(6)
    v_pk_add_f32 v[52:53], v[52:53], v[36:37]
    v_pk_add_f32 v[54:55], v[54:55], v[38:39]
    v_pk_add_f32 v[52:53], v[52:53], v[112:113]
    v_pk_add_f32 v[54:55], v[54:55], v[114:115]
    v_pk_add_f32 v[52:53], v[52:53], v[136:137]
    v_pk_add_f32 v[54:55], v[54:55], v[138:139]
    s_waitcnt lgkmcnt(3)
    v_pk_add_f32 v[48:49], v[48:49], v[32:33]
    v_pk_add_f32 v[50:51], v[50:51], v[34:35]
    v_pk_add_f32 v[48:49], v[48:49], v[108:109]
    v_pk_add_f32 v[50:51], v[50:51], v[110:111]
    v_pk_add_f32 v[48:49], v[48:49], v[132:133]
    v_pk_add_f32 v[50:51], v[50:51], v[134:135]
    s_waitcnt lgkmcnt(0)
    v_pk_add_f32 v[56:57], v[56:57], v[40:41]
    v_pk_add_f32 v[58:59], v[58:59], v[42:43]
    v_pk_add_f32 v[56:57], v[56:57], v[116:117]
    v_pk_add_f32 v[58:59], v[58:59], v[118:119]
    v_pk_add_f32 v[56:57], v[56:57], v[140:141]
    v_pk_add_f32 v[58:59], v[58:59], v[142:143]
    v_and_b32 v1, 3, v84
    v_mov_b32 v2, v64
    v_cmp_eq_u32 vcc, 1, v1
    s_nop 1
    v_cndmask_b32 v2, v2, v65, vcc
    v_cmp_eq_u32 vcc, 2, v1
    s_nop 1
    v_cndmask_b32 v2, v2, v66, vcc
    v_cmp_eq_u32 vcc, 3, v1
    s_nop 1
    v_cndmask_b32 v2, v2, v67, vcc
    v_lshrrev_b32 v1, 2, v84
    v_lshl_add_u32 v1, v1, 4, v84
    v_lshlrev_b32 v1, 2, v1
    ds_bpermute_b32 v78, v1, v2
    s_waitcnt lgkmcnt(0)
    v_mul_f32 v76, 0x3acccccd, v60
    v_mul_f32 v1, 0x3acccccd, v78
    v_fma_f32 v1, -v76, v76, v1
    v_max_f32 v1, 0, v1
    v_cvt_pk_bf16_f32 v76, v76, v76
    v_lshlrev_b32 v76, 16, v76
    v_cvt_pk_bf16_f32 v1, v1, v1
    v_lshlrev_b32 v1, 16, v1
    v_add_f32 v1, 0x3727c5ac, v1
    v_cvt_pk_bf16_f32 v1, v1, v1
    v_lshlrev_b32 v1, 16, v1
    v_sqrt_f32 v1, v1
    s_nop 0
    v_cvt_pk_bf16_f32 v1, v1, v1
    v_lshlrev_b32 v1, 16, v1
    v_rcp_f32 v77, v1
    s_nop 0
    v_fma_f32 v44, -v76, v52, v44
    v_mul_f32 v44, v44, v77
    v_fma_f32 v45, -v76, v53, v45
    v_mul_f32 v45, v45, v77
    v_fma_f32 v46, -v76, v54, v46
    v_mul_f32 v46, v46, v77
    v_fma_f32 v47, -v76, v55, v47
    v_mul_f32 v47, v47, v77
    v_cvt_pk_bf16_f32 v44, v44, v45
    v_cvt_pk_bf16_f32 v45, v46, v47
    v_fma_f32 v48, -v76, v56, v48
    v_mul_f32 v48, v48, v77
    v_fma_f32 v49, -v76, v57, v49
    v_mul_f32 v49, v49, v77
    v_fma_f32 v50, -v76, v58, v50
    v_mul_f32 v50, v50, v77
    v_fma_f32 v51, -v76, v59, v51
    v_mul_f32 v51, v51, v77
    v_cvt_pk_bf16_f32 v48, v48, v49
    v_cvt_pk_bf16_f32 v49, v50, v51
    v_mov_b32 v78, 0
    s_bitcmp1_b32 s12, 2
    s_cbranch_scc1 fz_4
    v_lshrrev_b32 v1, 1, v85
    v_lshlrev_b32 v1, 8, v1
    v_lshl_add_u32 v1, v84, 4, v1
    v_and_b32 v2, 1, v85
    v_lshl_add_u32 v1, v2, 3, v1
    ds_write_b64 v1, v[44:45] offset:49152
    v_lshlrev_b32 v2, 3, v84
    s_mov_b64 exec, 0xffff
    ds_write_b64 v2, v[48:49] offset:49664
    v_lshlrev_b32 v1, 16, v48
    v_and_b32 v2, 0xffff0000, v48
    v_fma_f32 v78, v1, v1, v78
    v_fma_f32 v78, v2, v2, v78
    v_lshlrev_b32 v1, 16, v49
    v_and_b32 v2, 0xffff0000, v49
    v_fma_f32 v78, v1, v1, v78
    v_fma_f32 v78, v2, v2, v78
    s_mov_b64 exec, -1
    v_lshlrev_b32 v1, 16, v44
    v_and_b32 v2, 0xffff0000, v44
    v_fma_f32 v78, v1, v1, v78
    v_fma_f32 v78, v2, v2, v78
    v_lshlrev_b32 v1, 16, v45
    v_and_b32 v2, 0xffff0000, v45
    v_fma_f32 v78, v1, v1, v78
    v_fma_f32 v78, v2, v2, v78
    v_mov_b32 v1, v78
    s_nop 1
    v_permlane32_swap_b32 v78, v1
    s_nop 1
    v_add_f32 v78, v78, v1
    v_mov_b32 v1, v78
    s_nop 1
    v_permlane16_swap_b32 v78, v1
    s_nop 1
    v_add_f32 v78, v78, v1
    s_nop 1
    v_max_f32_dpp v78, v78, v78 row_shr:1 row_mask:0xf bank_mask:0xf bound_ctrl:0
    s_nop 1
    v_max_f32_dpp v78, v78, v78 row_shr:2 row_mask:0xf bank_mask:0xf bound_ctrl:0
    s_nop 1
    v_max_f32_dpp v78, v78, v78 row_shr:4 row_mask:0xf bank_mask:0xf bound_ctrl:0
    s_nop 1
    v_max_f32_dpp v78, v78, v78 row_shr:8 row_mask:0xf bank_mask:0xf bound_ctrl:0
    s_mov_b64 exec, 0x8000
    buffer_store_dword v78, v72, s[52:55], s65 offen sc1
    s_mov_b64 exec, -1
    v_lshlrev_b32 v1, 9, v85
    v_lshl_add_u32 v75, v84, 4, v1
    s_lshl_b32 s70, s70, 7
    v_cmp_gt_u32 vcc, 2, v85
    v_mov_b32 v1, s70
    v_cndmask_b32 v2, 0, v1, vcc
    v_add3_u32 v75, v75, v1, v2
    s_branch fz_5
fz_4:
    v_bfe_u32 v1, v84, 2, 1
    v_mul_u32_u24 v1, 320, v1
    v_bfe_u32 v2, v84, 3, 1
    v_lshl_add_u32 v1, v2, 3, v1
    v_and_b32 v2, 3, v84
    v_lshl_add_u32 v1, v2, 1, v1
    v_lshl_add_u32 v1, v85, 6, v1
    ds_write_b16 v1, v44 offset:49152
    ds_write_b16_d16_hi v1, v44 offset:49168
    ds_write_b16 v1, v45 offset:49184
    ds_write_b16_d16_hi v1, v45 offset:49200
    s_mov_b64 exec, 0xffff
    ds_write_b16 v1, v48 offset:49408
    ds_write_b16_d16_hi v1, v48 offset:49424
    ds_write_b16 v1, v49 offset:49440
    ds_write_b16_d16_hi v1, v49 offset:49456
    s_mov_b64 exec, -1
    s_mul_i32 s70, s70, 640
    s_add_u32 s70, s70, 1280
    v_lshl_add_u32 v75, v83, 4, s70
fz_5:
    v_lshlrev_b32 v1, 4, v83
    ds_read_b128 v[52:55], v1 offset:49152
    s_mov_b32 exec_hi, 0xff
    s_waitcnt lgkmcnt(0)
    buffer_store_dwordx4 v[52:55], v75, s[44:47], s66 offen sc1
    s_mov_b64 exec, -1
fz_3:
    s_mov_b32 s76, 5
    s_mov_b32 s77, 36864
    s_barrier
    ds_read_b128 v[136:139], v90 offset:0
    ds_read_b128 v[140:143], v92 offset:0
    ds_read_b64_tr_b16 v[96:97], v89 offset:16384
    ds_read_b64_tr_b16 v[98:99], v89 offset:17664
    ds_read_b64_tr_b16 v[100:101], v89 offset:16416
    ds_read_b64_tr_b16 v[102:103], v89 offset:17696
    ds_read_b64_tr_b16 v[104:105], v89 offset:16448
    ds_read_b64_tr_b16 v[106:107], v89 offset:17728
    ds_read_b64_tr_b16 v[108:109], v89 offset:16480
    ds_read_b64_tr_b16 v[110:111], v89 offset:17760
    ds_read_b64_tr_b16 v[112:113], v89 offset:16512
    ds_read_b64_tr_b16 v[114:115], v89 offset:17792
k1q_loop:
    s_waitcnt lgkmcnt(0)
    v_mfma_f32_16x16x32_bf16 v[152:155], v[96:99], v[136:139], v[152:155]
    ds_read_b128 v[144:147], v91 offset:0
    v_mfma_f32_16x16x32_bf16 v[172:175], v[96:99], v[140:143], v[172:175]
    ds_read_b128 v[148:151], v93 offset:0
    v_mfma_f32_16x16x32_bf16 v[212:215], v[96:99], v[192:195], v[212:215]
    ds_read_b64_tr_b16 v[116:117], v89 offset:21504
    v_mfma_f32_16x16x32_bf16 v[156:159], v[100:103], v[136:139], v[156:159]
    ds_read_b64_tr_b16 v[118:119], v89 offset:22784
    v_mfma_f32_16x16x32_bf16 v[176:179], v[100:103], v[140:143], v[176:179]
    ds_read_b64_tr_b16 v[120:121], v89 offset:21536
    v_mfma_f32_16x16x32_bf16 v[216:219], v[100:103], v[192:195], v[216:219]
    ds_read_b64_tr_b16 v[122:123], v89 offset:22816
    v_mfma_f32_16x16x32_bf16 v[160:163], v[104:107], v[136:139], v[160:163]
    ds_read_b64_tr_b16 v[124:125], v89 offset:21568
    v_mfma_f32_16x16x32_bf16 v[180:183], v[104:107], v[140:143], v[180:183]
    ds_read_b64_tr_b16 v[126:127], v89 offset:22848
    v_mfma_f32_16x16x32_bf16 v[220:223], v[104:107], v[192:195], v[220:223]
    ds_read_b64_tr_b16 v[128:129], v89 offset:21600
    v_mfma_f32_16x16x32_bf16 v[164:167], v[108:111], v[136:139], v[164:167]
    ds_read_b64_tr_b16 v[130:131], v89 offset:22880
    v_mfma_f32_16x16x32_bf16 v[184:187], v[108:111], v[140:143], v[184:187]
    ds_read_b64_tr_b16 v[132:133], v89 offset:21632
    v_mfma_f32_16x16x32_bf16 v[224:227], v[108:111], v[192:195], v[224:227]
    ds_read_b64_tr_b16 v[134:135], v89 offset:22912
    v_mfma_f32_16x16x32_bf16 v[168:171], v[112:115], v[136:139], v[168:171]
    s_mov_b32 s79, s77
    s_add_u32 s77, s77, 36864
    v_mfma_f32_16x16x32_bf16 v[188:191], v[112:115], v[140:143], v[188:191]
    s_cmp_ge_u32 s77, 147456
    s_cselect_b32 s77, 0, s77
    s_sub_u32 s79, s77, s79
    v_mfma_f32_16x16x32_bf16 v[228:231], v[112:115], v[192:195], v[228:231]
    v_add_u32 v89, s79, v89
    v_mfma_f32_16x16x32_bf16 v[196:199], v[192:195], v[136:139], v[196:199]
    v_add_u32 v90, s79, v90
    v_mfma_f32_16x16x32_bf16 v[204:207], v[136:139], v[136:139], v[204:207]
    v_add_u32 v91, s79, v91
    v_mfma_f32_16x16x32_bf16 v[200:203], v[192:195], v[140:143], v[200:203]
    v_add_u32 v92, s79, v92
    v_mfma_f32_16x16x32_bf16 v[208:211], v[140:143], v[140:143], v[208:211]
    v_add_u32 v93, s79, v93
    s_waitcnt lgkmcnt(0)
    v_mfma_f32_16x16x32_bf16 v[152:155], v[116:119], v[144:147], v[152:155]
    s_cmp_eq_u32 s15, 0
    s_cbranch_scc1 hk_8
    s_sub_u32 s15, s15, 1
    s_mov_b64 exec, 1
    s_cmp_eq_u32 s15, 0
    s_cbranch_scc1 hk_9
    s_mov_b32 s71, 0x20000
hk_11:
    s_waitcnt vmcnt(0)
    v_readfirstlane_b32 s72, v71
    s_sub_u32 s71, s71, 1
    s_cmp_eq_u32 s71, 0
    s_cbranch_scc1 hk_12
    s_cmp_lg_u32 s72, 0
    s_cbranch_scc1 hk_12
    buffer_load_dword v71, v72, s[60:63], 0 offen offset:128 sc1
    s_branch hk_11
hk_12:
    v_mov_b32 v71, 1
    buffer_atomic_add v71, v72, s[8:11], s7 offen sc0 sc1
    s_branch hk_10
hk_9:
    s_waitcnt vmcnt(0)
    v_readfirstlane_b32 s72, v71
    v_mov_b32 v71, 1
    s_mov_b32 s7, 20480
    s_nop 2
    s_cmp_lg_u32 s72, 15
    s_cbranch_scc1 hk_10
    buffer_atomic_add v71, v72, s[8:11], s7 offen sc0 sc1
    s_waitcnt vmcnt(0)
    v_readfirstlane_b32 s72, v71
    s_nop 3
    s_cmp_lg_u32 s72, 15
    s_cbranch_scc1 hk_10
    s_mov_b64 exec, 0xff
    buffer_store_dword v73, v74, s[8:11], s7 offen offset:2048 sc1
hk_10:
    s_mov_b64 exec, -1
hk_8:
    s_cmp_lg_u32 s76, 2
    s_cbranch_scc1 hk_12x
    s_mul_i32 s71, s67, 40
    s_add_u32 s72, s71, 102400
    v_mul_u32_u24 v2, 160, v12
    v_add_u32 v24, s72, v2
    v_lshl_add_u32 v14, v13, 4, v24
    v_lshl_add_u32 v3, v13, 3, s71
    v_lshrrev_b32 v4, 4, v3
    v_and_b32 v3, 8, v3
    v_lshl_add_u32 v3, v4, 8, v3
    v_and_b32 v4, 15, v12
    v_lshl_add_u32 v3, v4, 4, v3
    v_lshrrev_b32 v4, 4, v12
    v_mul_u32_u24 v4, 2560, v4
    v_add_u32 v15, v3, v4
    v_mov_b32 v28, 0
    v_mov_b32 v29, 0
    v_mov_b32 v30, 0
    v_mov_b32 v31, 0
    v_mov_b32 v32, 0
    v_mov_b32 v33, 0
    v_mov_b32 v34, 0
    v_mov_b32 v35, 0
    v_mov_b32 v36, 0
    v_mov_b32 v37, 0
    v_mov_b32 v38, 0
    v_mov_b32 v39, 0
    v_mov_b32 v40, 0
    v_mov_b32 v41, 0
    v_mov_b32 v42, 0
    v_mov_b32 v43, 0
    v_mov_b32 v60, 0x3f803f80
    v_mov_b32 v61, 0x3f803f80
    v_mov_b32 v62, 0x3f803f80
    v_mov_b32 v63, 0x3f803f80
    v_mov_b32 v64, 0x3f803f80
    v_mov_b32 v65, 0x3f803f80
    v_mov_b32 v66, 0x3f803f80
    v_mov_b32 v67, 0x3f803f80
    v_mov_b32 v44, 0
    v_mov_b32 v45, 0
    v_mov_b32 v46, 0
    v_mov_b32 v47, 0
    v_mov_b32 v48, 0
    v_mov_b32 v49, 0
    v_mov_b32 v50, 0
    v_mov_b32 v51, 0
    v_mov_b32 v52, 0
    v_mov_b32 v53, 0
    v_mov_b32 v54, 0
    v_mov_b32 v55, 0
    v_mov_b32 v56, 0
    v_mov_b32 v57, 0
    v_mov_b32 v58, 0
    v_mov_b32 v59, 0
    v_mov_b32 v68, 0x3f803f80
    v_mov_b32 v69, 0x3f803f80
    v_mov_b32 v70, 0x3f803f80
    v_mov_b32 v71, 0x3f803f80
    v_mov_b32 v72, 0x3f803f80
    v_mov_b32 v73, 0x3f803f80
    v_mov_b32 v74, 0x3f803f80
    v_mov_b32 v75, 0x3f803f80
    s_mov_b32 s4, 0x000fffff
    s_mov_b32 s5, 0x000fffff
    v_mov_b32 v16, v10
    v_lshlrev_b32 v17, 3, v12
    v_add_u32 v17, 1024, v17
    v_mul_u32_u24 v1, 320, v13
    v_lshl_add_u32 v18, v12, 4, v1
    v_add_u32 v18, 1280, v18
    v_add_u32 v19, 20480, v16
    v_add_u32 v20, 20480, v17
    v_add_u32 v21, 20480, v18
hk_12x:
    s_barrier
    v_mfma_f32_16x16x32_bf16 v[172:175], v[116:119], v[148:151], v[172:175]
    ds_read_b128 v[136:139], v90 offset:0
    v_mfma_f32_16x16x32_bf16 v[212:215], v[116:119], v[192:195], v[212:215]
    ds_read_b128 v[140:143], v92 offset:0
    v_mfma_f32_16x16x32_bf16 v[156:159], v[120:123], v[144:147], v[156:159]
    ds_read_b64_tr_b16 v[96:97], v89 offset:16384
    v_mfma_f32_16x16x32_bf16 v[176:179], v[120:123], v[148:151], v[176:179]
    ds_read_b64_tr_b16 v[98:99], v89 offset:17664
    v_mfma_f32_16x16x32_bf16 v[216:219], v[120:123], v[192:195], v[216:219]
    ds_read_b64_tr_b16 v[100:101], v89 offset:16416
    v_mfma_f32_16x16x32_bf16 v[160:163], v[124:127], v[144:147], v[160:163]
    ds_read_b64_tr_b16 v[102:103], v89 offset:17696
    v_mfma_f32_16x16x32_bf16 v[180:183], v[124:127], v[148:151], v[180:183]
    ds_read_b64_tr_b16 v[104:105], v89 offset:16448
    v_mfma_f32_16x16x32_bf16 v[220:223], v[124:127], v[192:195], v[220:223]
    ds_read_b64_tr_b16 v[106:107], v89 offset:17728
    v_mfma_f32_16x16x32_bf16 v[164:167], v[128:131], v[144:147], v[164:167]
    ds_read_b64_tr_b16 v[108:109], v89 offset:16480
    v_mfma_f32_16x16x32_bf16 v[184:187], v[128:131], v[148:151], v[184:187]
    ds_read_b64_tr_b16 v[110:111], v89 offset:17760
    v_mfma_f32_16x16x32_bf16 v[224:227], v[128:131], v[192:195], v[224:227]
    ds_read_b64_tr_b16 v[112:113], v89 offset:16512
    v_mfma_f32_16x16x32_bf16 v[168:171], v[132:135], v[144:147], v[168:171]
    ds_read_b64_tr_b16 v[114:115], v89 offset:17792
    v_mfma_f32_16x16x32_bf16 v[188:191], v[132:135], v[148:151], v[188:191]
    s_sub_u32 s76, s76, 1
    s_cmp_lg_u32 s76, 0
    v_mfma_f32_16x16x32_bf16 v[228:231], v[132:135], v[192:195], v[228:231]
    v_mfma_f32_16x16x32_bf16 v[196:199], v[192:195], v[144:147], v[196:199]
    v_mfma_f32_16x16x32_bf16 v[204:207], v[144:147], v[144:147], v[204:207]
    v_mfma_f32_16x16x32_bf16 v[200:203], v[192:195], v[148:151], v[200:203]
    v_mfma_f32_16x16x32_bf16 v[208:211], v[148:151], v[148:151], v[208:211]
    s_cbranch_scc1 k1q_loop
    s_waitcnt vmcnt(0) lgkmcnt(0)
    s_nop 3
    ds_write_b128 v79, v[208:211] offset:5120
    ds_write_b32 v79, v200 offset:6144
    ds_write_b128 v79, v[172:175] offset:0
    ds_write_b128 v79, v[176:179] offset:1024
    ds_write_b128 v79, v[180:183] offset:2048
    ds_write_b128 v79, v[184:187] offset:3072
    ds_write_b128 v79, v[188:191] offset:4096
    s_mov_b32 exec_lo, 0x00010001
    s_mov_b32 exec_hi, 0x00010001
    ds_write_b128 v79, v[212:215] offset:7168
    ds_write_b128 v79, v[216:219] offset:7184
    ds_write_b128 v79, v[220:223] offset:7200
    ds_write_b128 v79, v[224:227] offset:7216
    ds_write_b128 v79, v[228:231] offset:7232
    s_mov_b64 exec, -1
    s_waitcnt lgkmcnt(0)
    s_barrier
    ds_read_b128 v[208:211], v80 offset:5120
    ds_read_b32 v200, v80 offset:6144
    ds_read_b128 v[172:175], v80 offset:0
    ds_read_b128 v[96:99], v81 offset:7168
    ds_read_b128 v[176:179], v80 offset:1024
    ds_read_b128 v[100:103], v81 offset:7184
    ds_read_b128 v[180:183], v80 offset:2048
    ds_read_b128 v[104:107], v81 offset:7200
    ds_read_b128 v[184:187], v80 offset:3072
    ds_read_b128 v[108:111], v81 offset:7216
    ds_read_b128 v[188:191], v80 offset:4096
    ds_read_b128 v[112:115], v81 offset:7232
    s_waitcnt lgkmcnt(10)
    v_add_f32 v196, v196, v200
    v_pk_add_f32 v[204:205], v[204:205], v[208:209]
    v_pk_add_f32 v[206:207], v[206:207], v[210:211]
    v_and_b32 v1, 3, v84
    v_mov_b32 v2, v204
    v_cmp_eq_u32 vcc, 1, v1
    s_nop 1
    v_cndmask_b32 v2, v2, v205, vcc
    v_cmp_eq_u32 vcc, 2, v1
    s_nop 1
    v_cndmask_b32 v2, v2, v206, vcc
    v_cmp_eq_u32 vcc, 3, v1
    s_nop 1
    v_cndmask_b32 v2, v2, v207, vcc
    v_lshrrev_b32 v1, 2, v84
    v_lshl_add_u32 v1, v1, 4, v84
    v_lshlrev_b32 v1, 2, v1
    ds_bpermute_b32 v78, v1, v2
    s_waitcnt lgkmcnt(0)
    v_pk_add_f32 v[152:153], v[152:153], v[172:173]
    v_pk_add_f32 v[212:213], v[212:213], v[96:97]
    v_pk_add_f32 v[154:155], v[154:155], v[174:175]
    v_pk_add_f32 v[214:215], v[214:215], v[98:99]
    v_pk_add_f32 v[156:157], v[156:157], v[176:177]
    v_pk_add_f32 v[216:217], v[216:217], v[100:101]
    v_pk_add_f32 v[158:159], v[158:159], v[178:179]
    v_pk_add_f32 v[218:219], v[218:219], v[102:103]
    v_pk_add_f32 v[160:161], v[160:161], v[180:181]
    v_pk_add_f32 v[220:221], v[220:221], v[104:105]
    v_pk_add_f32 v[162:163], v[162:163], v[182:183]
    v_pk_add_f32 v[222:223], v[222:223], v[106:107]
    v_pk_add_f32 v[164:165], v[164:165], v[184:185]
    v_pk_add_f32 v[224:225], v[224:225], v[108:109]
    v_pk_add_f32 v[166:167], v[166:167], v[186:187]
    v_pk_add_f32 v[226:227], v[226:227], v[110:111]
    v_pk_add_f32 v[168:169], v[168:169], v[188:189]
    v_pk_add_f32 v[228:229], v[228:229], v[112:113]
    v_pk_add_f32 v[170:171], v[170:171], v[190:191]
    v_pk_add_f32 v[230:231], v[230:231], v[114:115]
    v_mul_f32 v76, 0x3acccccd, v196
    v_mul_f32 v1, 0x3acccccd, v78
    v_fma_f32 v1, -v76, v76, v1
    v_max_f32 v1, 0, v1
    v_cvt_pk_bf16_f32 v76, v76, v76
    v_lshlrev_b32 v76, 16, v76
    v_cvt_pk_bf16_f32 v1, v1, v1
    v_lshlrev_b32 v1, 16, v1
    v_add_f32 v1, 0x3727c5ac, v1
    v_cvt_pk_bf16_f32 v1, v1, v1
    v_lshlrev_b32 v1, 16, v1
    v_sqrt_f32 v1, v1
    s_nop 0
    v_cvt_pk_bf16_f32 v1, v1, v1
    v_lshlrev_b32 v1, 16, v1
    v_rcp_f32 v77, v1
    s_nop 0
    v_mul_f32 v77, 0x3ea52b5c, v77
    v_sub_f32 v76, 0, v76
    v_pk_fma_f32 v[152:153], v[76:77], v[212:213], v[152:153] op_sel_hi:[0,1,1]
    v_pk_fma_f32 v[154:155], v[76:77], v[214:215], v[154:155] op_sel_hi:[0,1,1]
    v_pk_mul_f32 v[152:153], v[152:153], v[76:77] op_sel:[0,1] op_sel_hi:[1,1]
    v_pk_mul_f32 v[154:155], v[154:155], v[76:77] op_sel:[0,1] op_sel_hi:[1,1]
    v_cvt_pk_bf16_f32 v152, v152, v153
    v_cvt_pk_bf16_f32 v153, v154, v155
    ds_write_b64 v82, v[152:153] offset:0
    v_pk_fma_f32 v[156:157], v[76:77], v[216:217], v[156:157] op_sel_hi:[0,1,1]
    v_pk_fma_f32 v[158:159], v[76:77], v[218:219], v[158:159] op_sel_hi:[0,1,1]
    v_pk_mul_f32 v[156:157], v[156:157], v[76:77] op_sel:[0,1] op_sel_hi:[1,1]
    v_pk_mul_f32 v[158:159], v[158:159], v[76:77] op_sel:[0,1] op_sel_hi:[1,1]
    v_cvt_pk_bf16_f32 v156, v156, v157
    v_cvt_pk_bf16_f32 v157, v158, v159
    ds_write_b64 v82, v[156:157] offset:32
    v_pk_fma_f32 v[160:161], v[76:77], v[220:221], v[160:161] op_sel_hi:[0,1,1]
    v_pk_fma_f32 v[162:163], v[76:77], v[222:223], v[162:163] op_sel_hi:[0,1,1]
    v_pk_mul_f32 v[160:161], v[160:161], v[76:77] op_sel:[0,1] op_sel_hi:[1,1]
    v_pk_mul_f32 v[162:163], v[162:163], v[76:77] op_sel:[0,1] op_sel_hi:[1,1]
    v_cvt_pk_bf16_f32 v160, v160, v161
    v_cvt_pk_bf16_f32 v161, v162, v163
    ds_write_b64 v82, v[160:161] offset:64
    v_pk_fma_f32 v[164:165], v[76:77], v[224:225], v[164:165] op_sel_hi:[0,1,1]
    v_pk_fma_f32 v[166:167], v[76:77], v[226:227], v[166:167] op_sel_hi:[0,1,1]
    v_pk_mul_f32 v[164:165], v[164:165], v[76:77] op_sel:[0,1] op_sel_hi:[1,1]
    v_pk_mul_f32 v[166:167], v[166:167], v[76:77] op_sel:[0,1] op_sel_hi:[1,1]
    v_cvt_pk_bf16_f32 v164, v164, v165
    v_cvt_pk_bf16_f32 v165, v166, v167
    ds_write_b64 v82, v[164:165] offset:96
    v_pk_fma_f32 v[168:169], v[76:77], v[228:229], v[168:169] op_sel_hi:[0,1,1]
    v_pk_fma_f32 v[170:171], v[76:77], v[230:231], v[170:171] op_sel_hi:[0,1,1]
    v_pk_mul_f32 v[168:169], v[168:169], v[76:77] op_sel:[0,1] op_sel_hi:[1,1]
    v_pk_mul_f32 v[170:171], v[170:171], v[76:77] op_sel:[0,1] op_sel_hi:[1,1]
    v_cvt_pk_bf16_f32 v168, v168, v169
    v_cvt_pk_bf16_f32 v169, v170, v171
    ds_write_b64 v82, v[168:169] offset:128
    v_mov_b32 v178, 0x3f80
    v_mov_b32 v179, 0
    v_mov_b32 v83, 0
    v_mov_b32 v186, 0x3f80
    v_mov_b32 v187, 0
    v_mov_b32 v91, 0
    v_mov_b32 v164, 0
    v_mov_b32 v165, 0
    v_mov_b32 v166, 0
    v_mov_b32 v167, 0
    v_mov_b32 v168, 0
    v_mov_b32 v169, 0
    v_mov_b32 v170, 0
    v_mov_b32 v171, 0
    v_mov_b32 v152, 0
    v_mov_b32 v153, 0
    v_mov_b32 v154, 0
    v_mov_b32 v155, 0
    v_cmp_eq_u32 vcc, 0, v13
    v_mov_b32 v1, 112640
    s_waitcnt lgkmcnt(0)
    s_barrier
    ds_read_b32 v8, v1
    ds_read_b64 v[76:77], v14 offset:0
    ds_read_b64 v[78:79], v14 offset:8
    ds_read_b64 v[80:81], v24 offset:32
    ds_read_b64 v[84:85], v14 offset:5120
    ds_read_b64 v[86:87], v14 offset:5128
    ds_read_b64 v[88:89], v24 offset:5152
    ds_read_b128 v[172:175], v16 offset:0
    ds_read_b64 v[176:177], v17 offset:0
    ds_read_b128 v[180:183], v16 offset:2560
    ds_read_b64 v[184:185], v17 offset:2560
    s_mov_b64 exec, s[4:5]
    ds_read_b128 v[60:63], v18 offset:0
    ds_read_b128 v[64:67], v18 offset:640
    s_mov_b64 exec, -1
    s_waitcnt lgkmcnt(6)
    v_readfirstlane_b32 s6, v8
    v_cndmask_b32 v80, 0, v80, vcc
    v_cndmask_b32 v81, 0, v81, vcc
    v_cndmask_b32 v88, 0, v88, vcc
    v_cndmask_b32 v89, 0, v89, vcc
    v_dot2_f32_bf16 v3, v76, v76, 0
    v_dot2_f32_bf16 v4, v84, v84, 0
    v_dot2_f32_bf16 v3, v77, v77, v3
    v_dot2_f32_bf16 v4, v85, v85, v4
    v_dot2_f32_bf16 v3, v78, v78, v3
    v_dot2_f32_bf16 v4, v86, v86, v4
    v_dot2_f32_bf16 v3, v79, v79, v3
    v_dot2_f32_bf16 v4, v87, v87, v4
    v_dot2_f32_bf16 v3, v80, v80, v3
    v_dot2_f32_bf16 v4, v88, v88, v4
    v_dot2_f32_bf16 v3, v81, v81, v3
    v_dot2_f32_bf16 v4, v89, v89, v4
    s_nop 2
    v_mov_b32 v1, v3
    v_mov_b32 v2, v4
    s_nop 1
    v_permlane32_swap_b32 v1, v3
    v_permlane32_swap_b32 v2, v4
    s_nop 1
    v_add_f32 v1, v1, v3
    v_add_f32 v2, v2, v4
    v_mul_f32 v1, s6, v1
    v_mul_f32 v2, s6, v2
    v_sqrt_f32 v1, v1
    v_sqrt_f32 v2, v2
    s_nop 0
    v_cvt_pk_bf16_f32 v1, -v1, 0
    v_cvt_pk_bf16_f32 v2, -v2, 0
    v_cndmask_b32 v82, 0, v1, vcc
    v_cndmask_b32 v90, 0, v2, vcc
    s_waitcnt lgkmcnt(0)
    v_mfma_f32_32x32x16_bf16 v[92:107], v[172:175], v[76:79], 0
    v_mfma_f32_32x32x16_bf16 v[92:107], v[176:179], v[80:83], v[92:107]
    v_mfma_f32_32x32x16_bf16 v[124:139], v[172:175], v[84:87], 0
    v_mfma_f32_32x32x16_bf16 v[124:139], v[176:179], v[88:91], v[124:139]
    s_nop 7
    s_nop 7
    s_mov_b32 s77, 8
k2_loop:
    s_waitcnt lgkmcnt(0)
    v_mfma_f32_32x32x16_bf16 v[108:123], v[180:183], v[76:79], 0
    ds_read_b128 v[172:175], v16 offset:5120
    ds_read_b64 v[176:177], v17 offset:5120
    v_cvt_pk_bf16_f32 v170, v152, v153
    v_cvt_pk_bf16_f32 v171, v154, v155
    v_exp_f32 v92, v92
    v_exp_f32 v93, v93
    v_exp_f32 v94, v94
    v_exp_f32 v95, v95
    v_mfma_f32_32x32x16_bf16 v[44:59], v[72:75], v[168:171], v[44:59]
    v_exp_f32 v96, v96
    v_exp_f32 v97, v97
    v_exp_f32 v98, v98
    v_exp_f32 v99, v99
    v_mfma_f32_32x32x16_bf16 v[108:123], v[184:187], v[80:83], v[108:123]
    s_mov_b64 exec, s[4:5]
    ds_read_b128 v[68:71], v18 offset:2560
    ds_read_b128 v[72:75], v18 offset:3200
    s_mov_b64 exec, -1
    v_cvt_pk_bf16_f32 v156, v92, v93
    v_cvt_pk_bf16_f32 v157, v94, v95
    v_cvt_pk_bf16_f32 v158, v96, v97
    v_cvt_pk_bf16_f32 v159, v98, v99
    v_exp_f32 v100, v100
    v_exp_f32 v101, v101
    v_exp_f32 v102, v102
    v_exp_f32 v103, v103
    v_mfma_f32_32x32x16_bf16 v[28:43], v[60:63], v[156:159], v[28:43]
    v_cvt_pk_bf16_f32 v160, v100, v101
    v_cvt_pk_bf16_f32 v161, v102, v103
    v_exp_f32 v104, v104
    v_exp_f32 v105, v105
    v_exp_f32 v106, v106
    v_exp_f32 v107, v107
    v_mfma_f32_32x32x16_bf16 v[140:155], v[180:183], v[84:87], 0
    v_cvt_pk_bf16_f32 v162, v104, v105
    v_cvt_pk_bf16_f32 v163, v106, v107
    v_exp_f32 v124, v124
    v_exp_f32 v125, v125
    v_exp_f32 v126, v126
    v_exp_f32 v127, v127
    v_mfma_f32_32x32x16_bf16 v[28:43], v[64:67], v[160:163], v[28:43]
    v_exp_f32 v128, v128
    v_exp_f32 v129, v129
    v_exp_f32 v130, v130
    v_exp_f32 v131, v131
    v_mfma_f32_32x32x16_bf16 v[140:155], v[184:187], v[88:91], v[140:155]
    v_cvt_pk_bf16_f32 v164, v124, v125
    v_cvt_pk_bf16_f32 v165, v126, v127
    v_cvt_pk_bf16_f32 v166, v128, v129
    v_cvt_pk_bf16_f32 v167, v130, v131
    v_exp_f32 v132, v132
    v_exp_f32 v133, v133
    v_exp_f32 v134, v134
    v_exp_f32 v135, v135
    v_mfma_f32_32x32x16_bf16 v[44:59], v[60:63], v[164:167], v[44:59]
    v_cvt_pk_bf16_f32 v168, v132, v133
    v_cvt_pk_bf16_f32 v169, v134, v135
    v_exp_f32 v136, v136
    v_exp_f32 v137, v137
    v_exp_f32 v138, v138
    v_exp_f32 v139, v139
    s_waitcnt lgkmcnt(0)
    v_mfma_f32_32x32x16_bf16 v[92:107], v[172:175], v[76:79], 0
    ds_read_b128 v[180:183], v16 offset:7680
    ds_read_b64 v[184:185], v17 offset:7680
    v_cvt_pk_bf16_f32 v170, v136, v137
    v_cvt_pk_bf16_f32 v171, v138, v139
    v_exp_f32 v108, v108
    v_exp_f32 v109, v109
    v_exp_f32 v110, v110
    v_exp_f32 v111, v111
    v_mfma_f32_32x32x16_bf16 v[44:59], v[64:67], v[168:171], v[44:59]
    v_exp_f32 v112, v112
    v_exp_f32 v113, v113
    v_exp_f32 v114, v114
    v_exp_f32 v115, v115
    v_mfma_f32_32x32x16_bf16 v[92:107], v[176:179], v[80:83], v[92:107]
    s_mov_b64 exec, s[4:5]
    ds_read_b128 v[60:63], v18 offset:5120
    ds_read_b128 v[64:67], v18 offset:5760
    s_mov_b64 exec, -1
    v_cvt_pk_bf16_f32 v156, v108, v109
    v_cvt_pk_bf16_f32 v157, v110, v111
    v_cvt_pk_bf16_f32 v158, v112, v113
    v_cvt_pk_bf16_f32 v159, v114, v115
    v_exp_f32 v116, v116
    v_exp_f32 v117, v117
    v_exp_f32 v118, v118
    v_exp_f32 v119, v119
    v_mfma_f32_32x32x16_bf16 v[28:43], v[68:71], v[156:159], v[28:43]
    v_cvt_pk_bf16_f32 v160, v116, v117
    v_cvt_pk_bf16_f32 v161, v118, v119
    v_exp_f32 v120, v120
    v_exp_f32 v121, v121
    v_exp_f32 v122, v122
    v_exp_f32 v123, v123
    v_mfma_f32_32x32x16_bf16 v[124:139], v[172:175], v[84:87], 0
    v_cvt_pk_bf16_f32 v162, v120, v121
    v_cvt_pk_bf16_f32 v163, v122, v123
    v_exp_f32 v140, v140
    v_exp_f32 v141, v141
    v_exp_f32 v142, v142
    v_exp_f32 v143, v143
    v_mfma_f32_32x32x16_bf16 v[28:43], v[72:75], v[160:163], v[28:43]
    v_exp_f32 v144, v144
    v_exp_f32 v145, v145
    v_exp_f32 v146, v146
    v_exp_f32 v147, v147
    v_mfma_f32_32x32x16_bf16 v[124:139], v[176:179], v[88:91], v[124:139]
    v_cvt_pk_bf16_f32 v164, v140, v141
    v_cvt_pk_bf16_f32 v165, v142, v143
    v_cvt_pk_bf16_f32 v166, v144, v145
    v_cvt_pk_bf16_f32 v167, v146, v147
    v_exp_f32 v148, v148
    v_exp_f32 v149, v149
    v_exp_f32 v150, v150
    v_exp_f32 v151, v151
    v_mfma_f32_32x32x16_bf16 v[44:59], v[68:71], v[164:167], v[44:59]
    v_cvt_pk_bf16_f32 v168, v148, v149
    v_cvt_pk_bf16_f32 v169, v150, v151
    v_exp_f32 v152, v152
    v_exp_f32 v153, v153
    v_exp_f32 v154, v154
    v_exp_f32 v155, v155
    s_bitcmp1_b32 0x140, s77
    s_cbranch_scc1 k2_sy
k2_nb1:
    s_waitcnt lgkmcnt(0)
    v_mfma_f32_32x32x16_bf16 v[108:123], v[180:183], v[76:79], 0
    ds_read_b128 v[172:175], v16 offset:10240
    ds_read_b64 v[176:177], v17 offset:10240
    v_cvt_pk_bf16_f32 v170, v152, v153
    v_cvt_pk_bf16_f32 v171, v154, v155
    v_exp_f32 v92, v92
    v_exp_f32 v93, v93
    v_exp_f32 v94, v94
    v_exp_f32 v95, v95
    v_mfma_f32_32x32x16_bf16 v[44:59], v[72:75], v[168:171], v[44:59]
    v_exp_f32 v96, v96
    v_exp_f32 v97, v97
    v_exp_f32 v98, v98
    v_exp_f32 v99, v99
    v_mfma_f32_32x32x16_bf16 v[108:123], v[184:187], v[80:83], v[108:123]
    s_mov_b64 exec, s[4:5]
    ds_read_b128 v[68:71], v18 offset:7680
    ds_read_b128 v[72:75], v18 offset:8320
    s_mov_b64 exec, -1
    v_cvt_pk_bf16_f32 v156, v92, v93
    v_cvt_pk_bf16_f32 v157, v94, v95
    v_cvt_pk_bf16_f32 v158, v96, v97
    v_cvt_pk_bf16_f32 v159, v98, v99
    v_exp_f32 v100, v100
    v_exp_f32 v101, v101
    v_exp_f32 v102, v102
    v_exp_f32 v103, v103
    v_mfma_f32_32x32x16_bf16 v[28:43], v[60:63], v[156:159], v[28:43]
    v_cvt_pk_bf16_f32 v160, v100, v101
    v_cvt_pk_bf16_f32 v161, v102, v103
    v_exp_f32 v104, v104
    v_exp_f32 v105, v105
    v_exp_f32 v106, v106
    v_exp_f32 v107, v107
    v_mfma_f32_32x32x16_bf16 v[140:155], v[180:183], v[84:87], 0
    v_cvt_pk_bf16_f32 v162, v104, v105
    v_cvt_pk_bf16_f32 v163, v106, v107
    v_exp_f32 v124, v124
    v_exp_f32 v125, v125
    v_exp_f32 v126, v126
    v_exp_f32 v127, v127
    v_mfma_f32_32x32x16_bf16 v[28:43], v[64:67], v[160:163], v[28:43]
    v_exp_f32 v128, v128
    v_exp_f32 v129, v129
    v_exp_f32 v130, v130
    v_exp_f32 v131, v131
    v_mfma_f32_32x32x16_bf16 v[140:155], v[184:187], v[88:91], v[140:155]
    v_cvt_pk_bf16_f32 v164, v124, v125
    v_cvt_pk_bf16_f32 v165, v126, v127
    v_cvt_pk_bf16_f32 v166, v128, v129
    v_cvt_pk_bf16_f32 v167, v130, v131
    v_exp_f32 v132, v132
    v_exp_f32 v133, v133
    v_exp_f32 v134, v134
    v_exp_f32 v135, v135
    v_mfma_f32_32x32x16_bf16 v[44:59], v[60:63], v[164:167], v[44:59]
    v_cvt_pk_bf16_f32 v168, v132, v133
    v_cvt_pk_bf16_f32 v169, v134, v135
    v_exp_f32 v136, v136
    v_exp_f32 v137, v137
    v_exp_f32 v138, v138
    v_exp_f32 v139, v139
    s_waitcnt lgkmcnt(0)
    v_mfma_f32_32x32x16_bf16 v[92:107], v[172:175], v[76:79], 0
    ds_read_b128 v[180:183], v16 offset:12800
    ds_read_b64 v[184:185], v17 offset:12800
    v_cvt_pk_bf16_f32 v170, v136, v137
    v_cvt_pk_bf16_f32 v171, v138, v139
    v_exp_f32 v108, v108
    v_exp_f32 v109, v109
    v_exp_f32 v110, v110
    v_exp_f32 v111, v111
    v_mfma_f32_32x32x16_bf16 v[44:59], v[64:67], v[168:171], v[44:59]
    v_exp_f32 v112, v112
    v_exp_f32 v113, v113
    v_exp_f32 v114, v114
    v_exp_f32 v115, v115
    v_mfma_f32_32x32x16_bf16 v[92:107], v[176:179], v[80:83], v[92:107]
    s_mov_b64 exec, s[4:5]
    ds_read_b128 v[60:63], v18 offset:10240
    ds_read_b128 v[64:67], v18 offset:10880
    s_mov_b64 exec, -1
    v_cvt_pk_bf16_f32 v156, v108, v109
    v_cvt_pk_bf16_f32 v157, v110, v111
    v_cvt_pk_bf16_f32 v158, v112, v113
    v_cvt_pk_bf16_f32 v159, v114, v115
    v_exp_f32 v116, v116
    v_exp_f32 v117, v117
    v_exp_f32 v118, v118
    v_exp_f32 v119, v119
    v_mfma_f32_32x32x16_bf16 v[28:43], v[68:71], v[156:159], v[28:43]
    v_cvt_pk_bf16_f32 v160, v116, v117
    v_cvt_pk_bf16_f32 v161, v118, v119
    v_exp_f32 v120, v120
    v_exp_f32 v121, v121
    v_exp_f32 v122, v122
    v_exp_f32 v123, v123
    v_mfma_f32_32x32x16_bf16 v[124:139], v[172:175], v[84:87], 0
    v_cvt_pk_bf16_f32 v162, v120, v121
    v_cvt_pk_bf16_f32 v163, v122, v123
    v_exp_f32 v140, v140
    v_exp_f32 v141, v141
    v_exp_f32 v142, v142
    v_exp_f32 v143, v143
    v_mfma_f32_32x32x16_bf16 v[28:43], v[72:75], v[160:163], v[28:43]
    v_exp_f32 v144, v144
    v_exp_f32 v145, v145
    v_exp_f32 v146, v146
    v_exp_f32 v147, v147
    v_mfma_f32_32x32x16_bf16 v[124:139], v[176:179], v[88:91], v[124:139]
    v_cvt_pk_bf16_f32 v164, v140, v141
    v_cvt_pk_bf16_f32 v165, v142, v143
    v_cvt_pk_bf16_f32 v166, v144, v145
    v_cvt_pk_bf16_f32 v167, v146, v147
    v_exp_f32 v148, v148
    v_exp_f32 v149, v149
    v_exp_f32 v150, v150
    v_exp_f32 v151, v151
    v_mfma_f32_32x32x16_bf16 v[44:59], v[68:71], v[164:167], v[44:59]
    v_cvt_pk_bf16_f32 v168, v148, v149
    v_cvt_pk_bf16_f32 v169, v150, v151
    v_exp_f32 v152, v152
    v_exp_f32 v153, v153
    v_exp_f32 v154, v154
    v_exp_f32 v155, v155
    s_waitcnt lgkmcnt(0)
    v_mfma_f32_32x32x16_bf16 v[108:123], v[180:183], v[76:79], 0
    ds_read_b128 v[172:175], v16 offset:15360
    ds_read_b64 v[176:177], v17 offset:15360
    v_cvt_pk_bf16_f32 v170, v152, v153
    v_cvt_pk_bf16_f32 v171, v154, v155
    v_exp_f32 v92, v92
    v_exp_f32 v93, v93
    v_exp_f32 v94, v94
    v_exp_f32 v95, v95
    v_mfma_f32_32x32x16_bf16 v[44:59], v[72:75], v[168:171], v[44:59]
    v_exp_f32 v96, v96
    v_exp_f32 v97, v97
    v_exp_f32 v98, v98
    v_exp_f32 v99, v99
    v_mfma_f32_32x32x16_bf16 v[108:123], v[184:187], v[80:83], v[108:123]
    s_mov_b64 exec, s[4:5]
    ds_read_b128 v[68:71], v18 offset:12800
    ds_read_b128 v[72:75], v18 offset:13440
    s_mov_b64 exec, -1
    v_cvt_pk_bf16_f32 v156, v92, v93
    v_cvt_pk_bf16_f32 v157, v94, v95
    v_cvt_pk_bf16_f32 v158, v96, v97
    v_cvt_pk_bf16_f32 v159, v98, v99
    v_exp_f32 v100, v100
    v_exp_f32 v101, v101
    v_exp_f32 v102, v102
    v_exp_f32 v103, v103
    v_mfma_f32_32x32x16_bf16 v[28:43], v[60:63], v[156:159], v[28:43]
    v_cvt_pk_bf16_f32 v160, v100, v101
    v_cvt_pk_bf16_f32 v161, v102, v103
    v_exp_f32 v104, v104
    v_exp_f32 v105, v105
    v_exp_f32 v106, v106
    v_exp_f32 v107, v107
    v_mfma_f32_32x32x16_bf16 v[140:155], v[180:183], v[84:87], 0
    v_cvt_pk_bf16_f32 v162, v104, v105
    v_cvt_pk_bf16_f32 v163, v106, v107
    v_exp_f32 v124, v124
    v_exp_f32 v125, v125
    v_exp_f32 v126, v126
    v_exp_f32 v127, v127
    v_mfma_f32_32x32x16_bf16 v[28:43], v[64:67], v[160:163], v[28:43]
    v_exp_f32 v128, v128
    v_exp_f32 v129, v129
    v_exp_f32 v130, v130
    v_exp_f32 v131, v131
    v_mfma_f32_32x32x16_bf16 v[140:155], v[184:187], v[88:91], v[140:155]
    v_cvt_pk_bf16_f32 v164, v124, v125
    v_cvt_pk_bf16_f32 v165, v126, v127
    v_cvt_pk_bf16_f32 v166, v128, v129
    v_cvt_pk_bf16_f32 v167, v130, v131
    v_exp_f32 v132, v132
    v_exp_f32 v133, v133
    v_exp_f32 v134, v134
    v_exp_f32 v135, v135
    v_mfma_f32_32x32x16_bf16 v[44:59], v[60:63], v[164:167], v[44:59]
    v_cvt_pk_bf16_f32 v168, v132, v133
    v_cvt_pk_bf16_f32 v169, v134, v135
    v_exp_f32 v136, v136
    v_exp_f32 v137, v137
    v_exp_f32 v138, v138
    v_exp_f32 v139, v139
    s_waitcnt lgkmcnt(0)
    v_mfma_f32_32x32x16_bf16 v[92:107], v[172:175], v[76:79], 0
    ds_read_b128 v[180:183], v16 offset:17920
    ds_read_b64 v[184:185], v17 offset:17920
    v_cvt_pk_bf16_f32 v170, v136, v137
    v_cvt_pk_bf16_f32 v171, v138, v139
    v_exp_f32 v108, v108
    v_exp_f32 v109, v109
    v_exp_f32 v110, v110
    v_exp_f32 v111, v111
    v_mfma_f32_32x32x16_bf16 v[44:59], v[64:67], v[168:171], v[44:59]
    v_exp_f32 v112, v112
    v_exp_f32 v113, v113
    v_exp_f32 v114, v114
    v_exp_f32 v115, v115
    v_mfma_f32_32x32x16_bf16 v[92:107], v[176:179], v[80:83], v[92:107]
    s_mov_b64 exec, s[4:5]
    ds_read_b128 v[60:63], v18 offset:15360
    ds_read_b128 v[64:67], v18 offset:16000
    s_mov_b64 exec, -1
    v_cvt_pk_bf16_f32 v156, v108, v109
    v_cvt_pk_bf16_f32 v157, v110, v111
    v_cvt_pk_bf16_f32 v158, v112, v113
    v_cvt_pk_bf16_f32 v159, v114, v115
    v_exp_f32 v116, v116
    v_exp_f32 v117, v117
    v_exp_f32 v118, v118
    v_exp_f32 v119, v119
    v_mfma_f32_32x32x16_bf16 v[28:43], v[68:71], v[156:159], v[28:43]
    v_cvt_pk_bf16_f32 v160, v116, v117
    v_cvt_pk_bf16_f32 v161, v118, v119
    v_exp_f32 v120, v120
    v_exp_f32 v121, v121
    v_exp_f32 v122, v122
    v_exp_f32 v123, v123
    v_mfma_f32_32x32x16_bf16 v[124:139], v[172:175], v[84:87], 0
    v_cvt_pk_bf16_f32 v162, v120, v121
    v_cvt_pk_bf16_f32 v163, v122, v123
    v_exp_f32 v140, v140
    v_exp_f32 v141, v141
    v_exp_f32 v142, v142
    v_exp_f32 v143, v143
    v_mfma_f32_32x32x16_bf16 v[28:43], v[72:75], v[160:163], v[28:43]
    v_exp_f32 v144, v144
    v_exp_f32 v145, v145
    v_exp_f32 v146, v146
    v_exp_f32 v147, v147
    v_mfma_f32_32x32x16_bf16 v[124:139], v[176:179], v[88:91], v[124:139]
    v_cvt_pk_bf16_f32 v164, v140, v141
    v_cvt_pk_bf16_f32 v165, v142, v143
    v_cvt_pk_bf16_f32 v166, v144, v145
    v_cvt_pk_bf16_f32 v167, v146, v147
    v_exp_f32 v148, v148
    v_exp_f32 v149, v149
    v_exp_f32 v150, v150
    v_exp_f32 v151, v151
    v_mfma_f32_32x32x16_bf16 v[44:59], v[68:71], v[164:167], v[44:59]
    v_cvt_pk_bf16_f32 v168, v148, v149
    v_cvt_pk_bf16_f32 v169, v150, v151
    v_exp_f32 v152, v152
    v_exp_f32 v153, v153
    v_exp_f32 v154, v154
    v_exp_f32 v155, v155
    s_waitcnt lgkmcnt(0)
    v_mfma_f32_32x32x16_bf16 v[108:123], v[180:183], v[76:79], 0
    ds_read_b128 v[172:175], v19 offset:0
    ds_read_b64 v[176:177], v20 offset:0
    v_cvt_pk_bf16_f32 v170, v152, v153
    v_cvt_pk_bf16_f32 v171, v154, v155
    v_exp_f32 v92, v92
    v_exp_f32 v93, v93
    v_exp_f32 v94, v94
    v_exp_f32 v95, v95
    v_mfma_f32_32x32x16_bf16 v[44:59], v[72:75], v[168:171], v[44:59]
    v_exp_f32 v96, v96
    v_exp_f32 v97, v97
    v_exp_f32 v98, v98
    v_exp_f32 v99, v99
    v_mfma_f32_32x32x16_bf16 v[108:123], v[184:187], v[80:83], v[108:123]
    s_mov_b64 exec, s[4:5]
    ds_read_b128 v[68:71], v18 offset:17920
    ds_read_b128 v[72:75], v18 offset:18560
    s_mov_b64 exec, -1
    v_cvt_pk_bf16_f32 v156, v92, v93
    v_cvt_pk_bf16_f32 v157, v94, v95
    v_cvt_pk_bf16_f32 v158, v96, v97
    v_cvt_pk_bf16_f32 v159, v98, v99
    v_exp_f32 v100, v100
    v_exp_f32 v101, v101
    v_exp_f32 v102, v102
    v_exp_f32 v103, v103
    v_mfma_f32_32x32x16_bf16 v[28:43], v[60:63], v[156:159], v[28:43]
    v_cvt_pk_bf16_f32 v160, v100, v101
    v_cvt_pk_bf16_f32 v161, v102, v103
    v_exp_f32 v104, v104
    v_exp_f32 v105, v105
    v_exp_f32 v106, v106
    v_exp_f32 v107, v107
    v_mfma_f32_32x32x16_bf16 v[140:155], v[180:183], v[84:87], 0
    v_cvt_pk_bf16_f32 v162, v104, v105
    v_cvt_pk_bf16_f32 v163, v106, v107
    v_exp_f32 v124, v124
    v_exp_f32 v125, v125
    v_exp_f32 v126, v126
    v_exp_f32 v127, v127
    v_mfma_f32_32x32x16_bf16 v[28:43], v[64:67], v[160:163], v[28:43]
    v_exp_f32 v128, v128
    v_exp_f32 v129, v129
    v_exp_f32 v130, v130
    v_exp_f32 v131, v131
    v_mfma_f32_32x32x16_bf16 v[140:155], v[184:187], v[88:91], v[140:155]
    v_cvt_pk_bf16_f32 v164, v124, v125
    v_cvt_pk_bf16_f32 v165, v126, v127
    v_cvt_pk_bf16_f32 v166, v128, v129
    v_cvt_pk_bf16_f32 v167, v130, v131
    v_exp_f32 v132, v132
    v_exp_f32 v133, v133
    v_exp_f32 v134, v134
    v_exp_f32 v135, v135
    v_mfma_f32_32x32x16_bf16 v[44:59], v[60:63], v[164:167], v[44:59]
    v_cvt_pk_bf16_f32 v168, v132, v133
    v_cvt_pk_bf16_f32 v169, v134, v135
    v_exp_f32 v136, v136
    v_exp_f32 v137, v137
    v_exp_f32 v138, v138
    v_exp_f32 v139, v139
    s_waitcnt lgkmcnt(0)
    v_mfma_f32_32x32x16_bf16 v[92:107], v[172:175], v[76:79], 0
    ds_read_b128 v[180:183], v19 offset:2560
    ds_read_b64 v[184:185], v20 offset:2560
    v_cvt_pk_bf16_f32 v170, v136, v137
    v_cvt_pk_bf16_f32 v171, v138, v139
    v_exp_f32 v108, v108
    v_exp_f32 v109, v109
    v_exp_f32 v110, v110
    v_exp_f32 v111, v111
    v_mfma_f32_32x32x16_bf16 v[44:59], v[64:67], v[168:171], v[44:59]
    v_exp_f32 v112, v112
    v_exp_f32 v113, v113
    v_exp_f32 v114, v114
    v_exp_f32 v115, v115
    v_mfma_f32_32x32x16_bf16 v[92:107], v[176:179], v[80:83], v[92:107]
    s_mov_b64 exec, s[4:5]
    ds_read_b128 v[60:63], v21 offset:0
    ds_read_b128 v[64:67], v21 offset:640
    s_mov_b64 exec, -1
    v_cvt_pk_bf16_f32 v156, v108, v109
    v_cvt_pk_bf16_f32 v157, v110, v111
    v_cvt_pk_bf16_f32 v158, v112, v113
    v_cvt_pk_bf16_f32 v159, v114, v115
    v_exp_f32 v116, v116
    v_exp_f32 v117, v117
    v_exp_f32 v118, v118
    v_exp_f32 v119, v119
    v_mfma_f32_32x32x16_bf16 v[28:43], v[68:71], v[156:159], v[28:43]
    v_cvt_pk_bf16_f32 v160, v116, v117
    v_cvt_pk_bf16_f32 v161, v118, v119
    v_exp_f32 v120, v120
    v_exp_f32 v121, v121
    v_exp_f32 v122, v122
    v_exp_f32 v123, v123
    v_mfma_f32_32x32x16_bf16 v[124:139], v[172:175], v[84:87], 0
    v_cvt_pk_bf16_f32 v162, v120, v121
    v_cvt_pk_bf16_f32 v163, v122, v123
    v_exp_f32 v140, v140
    v_exp_f32 v141, v141
    v_exp_f32 v142, v142
    v_exp_f32 v143, v143
    v_mfma_f32_32x32x16_bf16 v[28:43], v[72:75], v[160:163], v[28:43]
    v_exp_f32 v144, v144
    v_exp_f32 v145, v145
    v_exp_f32 v146, v146
    v_exp_f32 v147, v147
    v_mfma_f32_32x32x16_bf16 v[124:139], v[176:179], v[88:91], v[124:139]
    v_cvt_pk_bf16_f32 v164, v140, v141
    v_cvt_pk_bf16_f32 v165, v142, v143
    v_cvt_pk_bf16_f32 v166, v144, v145
    v_cvt_pk_bf16_f32 v167, v146, v147
    v_exp_f32 v148, v148
    v_exp_f32 v149, v149
    v_exp_f32 v150, v150
    v_exp_f32 v151, v151
    v_mfma_f32_32x32x16_bf16 v[44:59], v[68:71], v[164:167], v[44:59]
    v_cvt_pk_bf16_f32 v168, v148, v149
    v_cvt_pk_bf16_f32 v169, v150, v151
    v_exp_f32 v152, v152
    v_exp_f32 v153, v153
    v_exp_f32 v154, v154
    v_exp_f32 v155, v155
    s_cmp_eq_u32 s77, 2
    s_cselect_b32 s76, 0, 20480
    v_mov_b32 v16, v19
    v_add_u32 v19, s76, v19
    v_mov_b32 v17, v20
    v_add_u32 v20, s76, v20
    v_mov_b32 v18, v21
    v_add_u32 v21, s76, v21
    s_cbranch_scc0 k2_nb
    s_mov_b64 exec, 1
    ds_add_u32 v10, v178
    s_mov_b64 exec, -1
k2_nb:
    s_sub_u32 s77, s77, 1
    s_cmp_lg_u32 s77, 0
    s_cbranch_scc1 k2_loop
    v_cvt_pk_bf16_f32 v170, v152, v153
    v_cvt_pk_bf16_f32 v171, v154, v155
    s_nop 1
    v_mfma_f32_32x32x16_bf16 v[44:59], v[72:75], v[168:171], v[44:59]
    s_waitcnt vmcnt(0) lgkmcnt(0)
    s_nop 7
    s_nop 7
    v_mov_b32 v1, 0x2b800000
    v_cmp_nge_f32 s[74:75], v40, v1
    v_cmp_nge_f32 vcc, v56, v1
    s_nop 3
    s_or_b64 vcc, vcc, s[74:75]
    s_cbranch_vccnz k2_slow
k2_epi:
    v_rcp_f32 v1, v40
    s_nop 0
    v_mul_f32 v28, v28, v1
    v_mul_f32 v29, v29, v1
    v_mul_f32 v30, v30, v1
    v_mul_f32 v31, v31, v1
    v_mul_f32 v32, v32, v1
    v_mul_f32 v33, v33, v1
    v_mul_f32 v34, v34, v1
    v_mul_f32 v35, v35, v1
    v_mul_f32 v36, v36, v1
    v_mul_f32 v37, v37, v1
    v_mul_f32 v38, v38, v1
    v_mul_f32 v39, v39, v1
    v_cvt_pk_bf16_f32 v28, v28, v29
    v_cvt_pk_bf16_f32 v29, v30, v31
    v_cvt_pk_bf16_f32 v30, v32, v33
    v_cvt_pk_bf16_f32 v31, v34, v35
    v_cvt_pk_bf16_f32 v32, v36, v37
    v_cvt_pk_bf16_f32 v33, v38, v39
    v_rcp_f32 v1, v56
    s_nop 0
    v_mul_f32 v44, v44, v1
    v_mul_f32 v45, v45, v1
    v_mul_f32 v46, v46, v1
    v_mul_f32 v47, v47, v1
    v_mul_f32 v48, v48, v1
    v_mul_f32 v49, v49, v1
    v_mul_f32 v50, v50, v1
    v_mul_f32 v51, v51, v1
    v_mul_f32 v52, v52, v1
    v_mul_f32 v53, v53, v1
    v_mul_f32 v54, v54, v1
    v_mul_f32 v55, v55, v1
    v_cvt_pk_bf16_f32 v44, v44, v45
    v_cvt_pk_bf16_f32 v45, v46, v47
    v_cvt_pk_bf16_f32 v46, v48, v49
    v_cvt_pk_bf16_f32 v47, v50, v51
    v_cvt_pk_bf16_f32 v48, v52, v53
    v_cvt_pk_bf16_f32 v49, v54, v55
    v_mov_b32 v1, 162816
    v_mov_b32 v156, 0
    v_mov_b32 v157, 0
    v_mov_b32 v158, 0
    v_mov_b32 v159, 0
    s_mul_i32 s71, s67, 2560
    v_add_u32 v2, s71, v10
    s_lshr_b32 s66, s68, 4
    s_add_u32 s66, s66, s67
    s_mul_i32 s66, s66, 20480
    s_lshl_b32 s71, s69, 4
    s_add_u32 s66, s66, s71
    s_barrier
    ds_write_b128 v1, v[156:159]
    ds_write_b64 v15, v[28:29] offset:0
    ds_write_b64 v15, v[30:31] offset:256
    ds_write_b64 v15, v[44:45] offset:5120
    ds_write_b64 v15, v[46:47] offset:5376
    s_mov_b64 exec, 0xffffffff
    ds_write_b64 v15, v[32:33] offset:512
    ds_write_b64 v15, v[48:49] offset:5632
    s_mov_b64 exec, -1
    s_waitcnt lgkmcnt(0)
    s_barrier
    ds_read_b128 v[28:31], v2 offset:0
    ds_read_b128 v[32:35], v2 offset:1024
    ds_read_b128 v[36:39], v2 offset:2048
    s_waitcnt lgkmcnt(2)
    buffer_store_dwordx4 v[28:31], v10, s[56:59], s66 offen offset:0 sc1
    s_waitcnt lgkmcnt(1)
    buffer_store_dwordx4 v[32:35], v10, s[56:59], s66 offen offset:1024 sc1
    s_waitcnt lgkmcnt(0)
    s_mov_b64 exec, 0xffffffff
    buffer_store_dwordx4 v[36:39], v10, s[56:59], s66 offen offset:2048 sc1
    s_mov_b32 s15, 0
    s_mov_b64 exec, 1
    v_mov_b32 v1, 162824
    v_mov_b32 v2, 1
    s_lshr_b32 s71, s68, 6
    s_lshl_b32 s71, s71, 8
    s_add_u32 s71, s71, 8192
    s_waitcnt vmcnt(0)
    ds_add_rtn_u32 v3, v1, v2
    v_mov_b32 v1, 0
    s_waitcnt lgkmcnt(0)
    v_readfirstlane_b32 s72, v3
    s_nop 3
    s_cmp_lg_u32 s72, 3
    s_cbranch_scc1 pub_13
    buffer_atomic_add v2, v1, s[8:11], s71 offen offset:128
    s_add_u32 s72, s71, 1
    s_cmp_eq_u32 s67, 0
    s_cselect_b32 s15, s72, 0
    s_cbranch_scc1 pub_13
    buffer_atomic_add v2, v1, s[8:11], s71 offen sc1
pub_13:
    s_mov_b64 exec, -1
    s_and_b32 s71, s2, 7
    s_lshr_b32 s70, s2, 3
    s_mov_b32 s12, s70
    s_mov_b32 s13, s71
    s_mul_i32 s73, s70, 52
    s_lshr_b32 s73, s73, 8
    s_mul_i32 s73, s73, 5
    s_sub_u32 s73, s70, s73
    s_lshr_b32 s72, s70, 3
    s_lshl_b32 s71, s71, 2
    s_add_u32 s71, s71, s72
    s_lshl_b32 s68, s71, 6
    s_and_b32 s70, s70, 7
    s_mul_i32 s69, s70, 160
    s_add_u32 s40, s38, 3018752
    s_addc_u32 s41, s39, 0
    s_mov_b32 s42, 2621440
    s_mov_b32 s43, 0x00020000
    s_add_u32 s44, s38, 14716928
    s_addc_u32 s45, s39, 0
    s_mov_b32 s46, 6717440
    s_mov_b32 s47, 0x00020000
    s_mul_i32 s14, s70, 102400
    s_add_u32 s48, s38, 5640192
    s_addc_u32 s49, s39, 0
    s_mov_b32 s50, 2621440
    s_mov_b32 s51, 0x00020000
    s_mov_b32 s52, s16
    s_mov_b32 s53, s17
    s_mov_b32 s54, 2621440
    s_mov_b32 s55, 0x00020000
    s_add_u32 s56, s38, 8261632
    s_addc_u32 s57, s39, 0
    s_mov_b32 s58, 131072
    s_mov_b32 s59, 0x00020000
    v_and_b32 v7, 63, v0
    v_lshrrev_b32 v10, 6, v0
    v_and_b32 v8, 15, v0
    v_bfe_u32 v9, v0, 4, 2
    v_and_b32 v11, 1, v10
    v_lshrrev_b32 v12, 1, v10
    v_lshrrev_b32 v1, 1, v9
    v_lshlrev_b32 v1, 4, v1
    v_and_b32 v2, 1, v9
    v_lshl_add_u32 v1, v2, 2, v1
    v_lshrrev_b32 v2, 2, v8
    v_add_u32 v1, v1, v2
    v_mov_b32 v2, 64
    v_mad_u32_u24 v1, v12, v2, v1
    v_mul_u32_u24 v1, 160, v1
    v_and_b32 v2, 3, v8
    v_lshl_add_u32 v1, v2, 3, v1
    v_mov_b32 v13, v1
    v_mul_u32_u24 v1, 8192, v11
    v_lshl_add_u32 v1, v7, 4, v1
    v_mul_u32_u24 v3, 2048, v12
    v_add_u32 v14, v1, v3
    v_mul_u32_u24 v1, 32, v11
    v_add_u32 v1, v1, v8
    v_and_b32 v2, 15, v1
    v_mul_u32_u24 v1, 256, v1
    v_mul_u32_u24 v3, 4096, v12
    v_sub_u32 v4, 4096, v3
    v_add_u32 v15, v4, v14
    v_add_u32 v14, v3, v14
    v_mov_b32 v72, 0
    v_mov_b32 v73, 0
    v_mov_b32 v74, 0
    v_mov_b32 v75, 0
    v_mov_b32 v76, 0
    v_mov_b32 v77, 0
    v_mov_b32 v78, 0
    v_mov_b32 v79, 0
    v_mov_b32 v80, 0
    v_mov_b32 v81, 0
    v_mov_b32 v82, 0
    v_mov_b32 v83, 0
    v_mov_b32 v84, 0
    v_mov_b32 v85, 0
    v_mov_b32 v86, 0
    v_mov_b32 v87, 0
    v_mov_b32 v88, 0
    v_mov_b32 v89, 0
    v_mov_b32 v90, 0
    v_mov_b32 v91, 0
    v_mov_b32 v92, 0
    v_mov_b32 v93, 0
    v_mov_b32 v94, 0
    v_mov_b32 v95, 0
    v_mov_b32 v96, 0
    v_mov_b32 v97, 0
    v_mov_b32 v98, 0
    v_mov_b32 v99, 0
    v_mov_b32 v100, 0
    v_mov_b32 v101, 0
    v_mov_b32 v102, 0
    v_mov_b32 v103, 0
    v_mov_b32 v104, 0
    v_mov_b32 v105, 0
    v_mov_b32 v106, 0
    v_mov_b32 v107, 0
    v_mov_b32 v108, 0
    v_mov_b32 v109, 0
    v_mov_b32 v110, 0
    v_mov_b32 v111, 0
    v_lshl_add_u32 v113, v11, 1, v12
    v_lshl_add_u32 v113, v113, 4, v8
    v_add_u32 v113, s68, v113
    v_mul_u32_u24 v1, 1280, v113
    v_add_u32 v1, s69, v1
    v_lshl_add_u32 v112, v9, 3, v1
    v_and_b32 v2, 1, v9
    v_lshl_add_u32 v114, v2, 5, v1
    v_lshrrev_b32 v2, 1, v9
    v_lshl_add_u32 v114, v2, 4, v114
    v_and_b32 v1, 0xfff0, v113
    v_mul_u32_u24 v1, 1280, v1
    v_lshl_add_u32 v1, v8, 4, v1
    s_lshl_b32 s71, s69, 4
    v_add_u32 v1, s71, v1
    v_lshl_add_u32 v1, v2, 8, v1
    v_and_b32 v2, 1, v9
    v_lshl_add_u32 v115, v2, 3, v1
    v_lshl_add_u32 v116, v2, 9, v1
    s_cmp_lg_u32 s67, 0
    s_cbranch_scc1 aw_15
    s_mov_b64 exec, 1
    v_mov_b32 v1, 0
    s_lshr_b32 s71, s68, 6
    s_lshl_b32 s71, s71, 8
    s_add_u32 s71, s71, 8192
    s_mov_b32 s65, 0x20000
aw_14:
    s_and_b32 s72, s65, 7
    s_cmp_eq_u32 s72, 1
    s_cbranch_scc1 aw_16
    v_mov_b32 v2, 0
    buffer_atomic_add v2, v1, s[8:11], s71 offen offset:128 sc0
    s_branch aw_17
aw_16:
    s_cmp_eq_u32 s15, 0
    s_cbranch_scc1 df_18
    s_sub_u32 s15, s15, 1
    v_mov_b32 v243, 1
    buffer_atomic_add v243, v1, s[8:11], s15 offen sc1
    s_mov_b32 s15, 0
df_18:
    buffer_load_dword v2, v1, s[8:11], s71 offen sc1
aw_17:
    s_sub_u32 s65, s65, 1
    s_waitcnt vmcnt(0)
    v_readfirstlane_b32 s72, v2
    s_cmp_eq_u32 s65, 0
    s_cselect_b32 s66, 8, 0
    s_max_u32 s72, s72, s66
    s_cmp_lt_u32 s72, 8
    s_cbranch_scc1 aw_14
    s_cmp_eq_u32 s15, 0
    s_cbranch_scc1 df_19
    s_sub_u32 s15, s15, 1
    v_mov_b32 v243, 1
    buffer_atomic_add v243, v1, s[8:11], s15 offen sc1
    s_mov_b32 s15, 0
df_19:
    s_mov_b64 exec, -1
aw_15:
    s_barrier
    s_mov_b32 s76, 5
    s_mov_b32 s77, 0
    s_barrier
    ds_read_b128 v[56:59], v14 offset:0
    ds_read_b128 v[60:63], v15 offset:0
    ds_read_b64_tr_b16 v[16:17], v13 offset:16384
    ds_read_b64_tr_b16 v[18:19], v13 offset:17664
    ds_read_b64_tr_b16 v[20:21], v13 offset:16416
    ds_read_b64_tr_b16 v[22:23], v13 offset:17696
    ds_read_b64_tr_b16 v[24:25], v13 offset:16448
    ds_read_b64_tr_b16 v[26:27], v13 offset:17728
    ds_read_b64_tr_b16 v[28:29], v13 offset:16480
    ds_read_b64_tr_b16 v[30:31], v13 offset:17760
    ds_read_b64_tr_b16 v[32:33], v13 offset:16512
    ds_read_b64_tr_b16 v[34:35], v13 offset:17792
k3_loop:
    s_waitcnt lgkmcnt(0)
    v_mfma_f32_16x16x32_bf16 v[72:75], v[16:19], v[56:59], v[72:75]
    ds_read_b128 v[64:67], v14 offset:1024
    ds_read_b128 v[68:71], v15 offset:1024
    v_mfma_f32_16x16x32_bf16 v[92:95], v[16:19], v[60:63], v[92:95]
    ds_read_b64_tr_b16 v[36:37], v13 offset:21504
    ds_read_b64_tr_b16 v[38:39], v13 offset:22784
    v_mfma_f32_16x16x32_bf16 v[76:79], v[20:23], v[56:59], v[76:79]
    ds_read_b64_tr_b16 v[40:41], v13 offset:21536
    ds_read_b64_tr_b16 v[42:43], v13 offset:22816
    v_mfma_f32_16x16x32_bf16 v[96:99], v[20:23], v[60:63], v[96:99]
    ds_read_b64_tr_b16 v[44:45], v13 offset:21568
    ds_read_b64_tr_b16 v[46:47], v13 offset:22848
    v_mfma_f32_16x16x32_bf16 v[80:83], v[24:27], v[56:59], v[80:83]
    ds_read_b64_tr_b16 v[48:49], v13 offset:21600
    ds_read_b64_tr_b16 v[50:51], v13 offset:22880
    v_mfma_f32_16x16x32_bf16 v[100:103], v[24:27], v[60:63], v[100:103]
    ds_read_b64_tr_b16 v[52:53], v13 offset:21632
    ds_read_b64_tr_b16 v[54:55], v13 offset:22912
    v_mfma_f32_16x16x32_bf16 v[84:87], v[28:31], v[56:59], v[84:87]
    s_mov_b32 s79, s77
    s_add_u32 s77, s77, 36864
    s_cmp_ge_u32 s77, 147456
    s_cselect_b32 s77, 0, s77
    s_sub_u32 s79, s77, s79
    v_mfma_f32_16x16x32_bf16 v[104:107], v[28:31], v[60:63], v[104:107]
    v_add_u32 v13, s79, v13
    v_add_u32 v14, s79, v14
    v_mfma_f32_16x16x32_bf16 v[88:91], v[32:35], v[56:59], v[88:91]
    v_add_u32 v15, s79, v15
    v_mfma_f32_16x16x32_bf16 v[108:111], v[32:35], v[60:63], v[108:111]
    s_waitcnt lgkmcnt(0)
    v_mfma_f32_16x16x32_bf16 v[72:75], v[36:39], v[64:67], v[72:75]
    s_barrier
    v_mfma_f32_16x16x32_bf16 v[92:95], v[36:39], v[68:71], v[92:95]
    ds_read_b128 v[56:59], v14 offset:0
    ds_read_b128 v[60:63], v15 offset:0
    v_mfma_f32_16x16x32_bf16 v[76:79], v[40:43], v[64:67], v[76:79]
    ds_read_b64_tr_b16 v[16:17], v13 offset:16384
    ds_read_b64_tr_b16 v[18:19], v13 offset:17664
    v_mfma_f32_16x16x32_bf16 v[96:99], v[40:43], v[68:71], v[96:99]
    ds_read_b64_tr_b16 v[20:21], v13 offset:16416
    ds_read_b64_tr_b16 v[22:23], v13 offset:17696
    v_mfma_f32_16x16x32_bf16 v[80:83], v[44:47], v[64:67], v[80:83]
    ds_read_b64_tr_b16 v[24:25], v13 offset:16448
    ds_read_b64_tr_b16 v[26:27], v13 offset:17728
    v_mfma_f32_16x16x32_bf16 v[100:103], v[44:47], v[68:71], v[100:103]
    ds_read_b64_tr_b16 v[28:29], v13 offset:16480
    ds_read_b64_tr_b16 v[30:31], v13 offset:17760
    v_mfma_f32_16x16x32_bf16 v[84:87], v[48:51], v[64:67], v[84:87]
    ds_read_b64_tr_b16 v[32:33], v13 offset:16512
    ds_read_b64_tr_b16 v[34:35], v13 offset:17792
    v_mfma_f32_16x16x32_bf16 v[104:107], v[48:51], v[68:71], v[104:107]
    s_sub_u32 s76, s76, 1
    s_cmp_lg_u32 s76, 0
    v_mfma_f32_16x16x32_bf16 v[88:91], v[52:55], v[64:67], v[88:91]
    v_mfma_f32_16x16x32_bf16 v[108:111], v[52:55], v[68:71], v[108:111]
    s_cbranch_scc1 k3_loop
    s_waitcnt vmcnt(0) lgkmcnt(0)
    s_nop 7
    v_mul_u32_u24 v1, 5120, v10
    v_lshl_add_u32 v1, v7, 4, v1
    v_add_u32 v1, 0, v1
    v_xor_b32 v2, 2, v10
    v_mul_u32_u24 v2, 5120, v2
    v_lshl_add_u32 v2, v7, 4, v2
    v_add_u32 v2, 0, v2
    ds_write_b128 v1, v[92:95] offset:0
    ds_write_b128 v1, v[96:99] offset:1024
    ds_write_b128 v1, v[100:103] offset:2048
    ds_write_b128 v1, v[104:107] offset:3072
    ds_write_b128 v1, v[108:111] offset:4096
    s_waitcnt lgkmcnt(0)
    s_barrier
    ds_read_b128 v[92:95], v2 offset:0
    ds_read_b128 v[96:99], v2 offset:1024
    ds_read_b128 v[100:103], v2 offset:2048
    ds_read_b128 v[104:107], v2 offset:3072
    ds_read_b128 v[108:111], v2 offset:4096
    v_mov_b32 v130, 0
    v_mov_b32 v131, 0
    v_mov_b32 v132, 0
    v_mov_b32 v133, 0
    s_waitcnt lgkmcnt(4)
    v_lshlrev_b32 v2, 16, v244
    v_and_b32 v3, 0xffff0000, v244
    v_pk_add_f32 v[72:73], v[72:73], v[92:93]
    v_cvt_pk_bf16_f32 v73, v72, v73
    v_lshlrev_b32 v72, 16, v73
    v_and_b32 v73, 0xffff0000, v73
    v_pk_add_f32 v[2:3], v[2:3], v[72:73]
    v_cvt_pk_bf16_f32 v92, v2, v3
    v_lshlrev_b32 v2, 16, v92
    v_and_b32 v3, 0xffff0000, v92
    v_pk_add_f32 v[130:131], v[130:131], v[2:3]
    v_pk_fma_f32 v[132:133], v[2:3], v[2:3], v[132:133]
    v_lshlrev_b32 v4, 16, v245
    v_and_b32 v5, 0xffff0000, v245
    v_pk_add_f32 v[74:75], v[74:75], v[94:95]
    v_cvt_pk_bf16_f32 v75, v74, v75
    v_lshlrev_b32 v74, 16, v75
    v_and_b32 v75, 0xffff0000, v75
    v_pk_add_f32 v[4:5], v[4:5], v[74:75]
    v_cvt_pk_bf16_f32 v93, v4, v5
    v_lshlrev_b32 v4, 16, v93
    v_and_b32 v5, 0xffff0000, v93
    v_pk_add_f32 v[130:131], v[130:131], v[4:5]
    v_pk_fma_f32 v[132:133], v[4:5], v[4:5], v[132:133]
    s_waitcnt lgkmcnt(3)
    v_lshlrev_b32 v2, 16, v246
    v_and_b32 v3, 0xffff0000, v246
    v_pk_add_f32 v[76:77], v[76:77], v[96:97]
    v_cvt_pk_bf16_f32 v77, v76, v77
    v_lshlrev_b32 v76, 16, v77
    v_and_b32 v77, 0xffff0000, v77
    v_pk_add_f32 v[2:3], v[2:3], v[76:77]
    v_cvt_pk_bf16_f32 v94, v2, v3
    v_lshlrev_b32 v2, 16, v94
    v_and_b32 v3, 0xffff0000, v94
    v_pk_add_f32 v[130:131], v[130:131], v[2:3]
    v_pk_fma_f32 v[132:133], v[2:3], v[2:3], v[132:133]
    v_lshlrev_b32 v4, 16, v247
    v_and_b32 v5, 0xffff0000, v247
    v_pk_add_f32 v[78:79], v[78:79], v[98:99]
    v_cvt_pk_bf16_f32 v79, v78, v79
    v_lshlrev_b32 v78, 16, v79
    v_and_b32 v79, 0xffff0000, v79
    v_pk_add_f32 v[4:5], v[4:5], v[78:79]
    v_cvt_pk_bf16_f32 v95, v4, v5
    v_lshlrev_b32 v4, 16, v95
    v_and_b32 v5, 0xffff0000, v95
    v_pk_add_f32 v[130:131], v[130:131], v[4:5]
    v_pk_fma_f32 v[132:133], v[4:5], v[4:5], v[132:133]
    s_nop 1
    v_permlane16_swap_b32 v92, v94
    v_permlane16_swap_b32 v93, v95
    buffer_store_dwordx4 v[92:95], v116, s[48:51], 0 offen offset:0 sc1
    s_waitcnt lgkmcnt(2)
    v_lshlrev_b32 v2, 16, v248
    v_and_b32 v3, 0xffff0000, v248
    v_pk_add_f32 v[80:81], v[80:81], v[100:101]
    v_cvt_pk_bf16_f32 v81, v80, v81
    v_lshlrev_b32 v80, 16, v81
    v_and_b32 v81, 0xffff0000, v81
    v_pk_add_f32 v[2:3], v[2:3], v[80:81]
    v_cvt_pk_bf16_f32 v100, v2, v3
    v_lshlrev_b32 v2, 16, v100
    v_and_b32 v3, 0xffff0000, v100
    v_pk_add_f32 v[130:131], v[130:131], v[2:3]
    v_pk_fma_f32 v[132:133], v[2:3], v[2:3], v[132:133]
    v_lshlrev_b32 v4, 16, v249
    v_and_b32 v5, 0xffff0000, v249
    v_pk_add_f32 v[82:83], v[82:83], v[102:103]
    v_cvt_pk_bf16_f32 v83, v82, v83
    v_lshlrev_b32 v82, 16, v83
    v_and_b32 v83, 0xffff0000, v83
    v_pk_add_f32 v[4:5], v[4:5], v[82:83]
    v_cvt_pk_bf16_f32 v101, v4, v5
    v_lshlrev_b32 v4, 16, v101
    v_and_b32 v5, 0xffff0000, v101
    v_pk_add_f32 v[130:131], v[130:131], v[4:5]
    v_pk_fma_f32 v[132:133], v[4:5], v[4:5], v[132:133]
    s_waitcnt lgkmcnt(1)
    v_lshlrev_b32 v2, 16, v250
    v_and_b32 v3, 0xffff0000, v250
    v_pk_add_f32 v[84:85], v[84:85], v[104:105]
    v_cvt_pk_bf16_f32 v85, v84, v85
    v_lshlrev_b32 v84, 16, v85
    v_and_b32 v85, 0xffff0000, v85
    v_pk_add_f32 v[2:3], v[2:3], v[84:85]
    v_cvt_pk_bf16_f32 v102, v2, v3
    v_lshlrev_b32 v2, 16, v102
    v_and_b32 v3, 0xffff0000, v102
    v_pk_add_f32 v[130:131], v[130:131], v[2:3]
    v_pk_fma_f32 v[132:133], v[2:3], v[2:3], v[132:133]
    v_lshlrev_b32 v4, 16, v251
    v_and_b32 v5, 0xffff0000, v251
    v_pk_add_f32 v[86:87], v[86:87], v[106:107]
    v_cvt_pk_bf16_f32 v87, v86, v87
    v_lshlrev_b32 v86, 16, v87
    v_and_b32 v87, 0xffff0000, v87
    v_pk_add_f32 v[4:5], v[4:5], v[86:87]
    v_cvt_pk_bf16_f32 v103, v4, v5
    v_lshlrev_b32 v4, 16, v103
    v_and_b32 v5, 0xffff0000, v103
    v_pk_add_f32 v[130:131], v[130:131], v[4:5]
    v_pk_fma_f32 v[132:133], v[4:5], v[4:5], v[132:133]
    s_nop 1
    v_permlane16_swap_b32 v100, v102
    v_permlane16_swap_b32 v101, v103
    buffer_store_dwordx4 v[100:103], v116, s[48:51], 0 offen offset:1024 sc1
    s_waitcnt lgkmcnt(0)
    v_lshlrev_b32 v2, 16, v252
    v_and_b32 v3, 0xffff0000, v252
    v_pk_add_f32 v[88:89], v[88:89], v[108:109]
    v_cvt_pk_bf16_f32 v89, v88, v89
    v_lshlrev_b32 v88, 16, v89
    v_and_b32 v89, 0xffff0000, v89
    v_pk_add_f32 v[2:3], v[2:3], v[88:89]
    v_cvt_pk_bf16_f32 v108, v2, v3
    v_lshlrev_b32 v2, 16, v108
    v_and_b32 v3, 0xffff0000, v108
    v_pk_add_f32 v[130:131], v[130:131], v[2:3]
    v_pk_fma_f32 v[132:133], v[2:3], v[2:3], v[132:133]
    v_lshlrev_b32 v4, 16, v253
    v_and_b32 v5, 0xffff0000, v253
    v_pk_add_f32 v[90:91], v[90:91], v[110:111]
    v_cvt_pk_bf16_f32 v91, v90, v91
    v_lshlrev_b32 v90, 16, v91
    v_and_b32 v91, 0xffff0000, v91
    v_pk_add_f32 v[4:5], v[4:5], v[90:91]
    v_cvt_pk_bf16_f32 v109, v4, v5
    v_lshlrev_b32 v4, 16, v109
    v_and_b32 v5, 0xffff0000, v109
    v_pk_add_f32 v[130:131], v[130:131], v[4:5]
    v_pk_fma_f32 v[132:133], v[4:5], v[4:5], v[132:133]
    buffer_store_dwordx2 v[108:109], v115, s[48:51], 0 offen offset:2048 sc1
    v_add_f32 v128, v130, v131
    v_add_f32 v129, v132, v133
    v_mov_b32 v1, v128
    v_mov_b32 v2, v129
    s_nop 1
    v_permlane32_swap_b32 v128, v1
    v_permlane32_swap_b32 v129, v2
    s_nop 1
    v_add_f32 v128, v128, v1
    v_add_f32 v129, v129, v2
    v_mov_b32 v1, v128
    v_mov_b32 v2, v129
    s_nop 1
    v_permlane16_swap_b32 v128, v1
    v_permlane16_swap_b32 v129, v2
    s_nop 1
    v_add_f32 v128, v128, v1
    v_add_f32 v129, v129, v2
    v_lshlrev_b32 v1, 3, v113
    s_lshl_b32 s70, s70, 14
    s_mov_b64 exec, 0xffff
    buffer_store_dwordx2 v[128:129], v1, s[56:59], s70 offen sc1
    s_mov_b32 s15, 0
    s_mov_b64 exec, 1
    v_mov_b32 v1, 162816
    v_mov_b32 v2, 1
    s_lshr_b32 s71, s68, 7
    s_lshl_b32 s71, s71, 8
    s_add_u32 s71, s71, 0
    s_waitcnt vmcnt(0)
    ds_add_rtn_u32 v3, v1, v2
    v_mov_b32 v1, 0
    s_waitcnt lgkmcnt(0)
    v_readfirstlane_b32 s72, v3
    s_nop 3
    s_cmp_lg_u32 s72, 3
    s_cbranch_scc1 pub_20
    buffer_atomic_add v2, v1, s[8:11], s71 offen offset:128
    s_add_u32 s72, s71, 1
    s_cmp_eq_u32 s67, 0
    s_cselect_b32 s15, s72, 0
    s_cbranch_scc1 pub_20
    buffer_atomic_add v2, v1, s[8:11], s71 offen sc1
pub_20:
    s_mov_b64 exec, -1
    s_and_b32 s13, s2, 7
    s_lshr_b32 s12, s2, 3
    s_mul_i32 s73, s12, 26
    s_lshr_b32 s73, s73, 8
    s_mul_i32 s73, s73, 10
    s_sub_u32 s73, s12, s73
    s_lshr_b32 s72, s13, 1
    s_lshl_b32 s72, s72, 2
    s_and_b32 s68, s12, 3
    s_add_u32 s68, s68, s72
    s_lshl_b32 s68, s68, 7
    s_lshr_b32 s72, s12, 2
    s_and_b32 s71, s13, 1
    s_lshl_b32 s71, s71, 3
    s_add_u32 s70, s72, s71
    s_mul_i32 s69, s70, 192
    s_mul_i32 s14, s70, 245760
    s_add_u32 s40, s38, 5640192
    s_addc_u32 s41, s39, 0
    s_mov_b32 s42, 2621440
    s_mov_b32 s43, 0x00020000
    s_add_u32 s44, s38, 14716928
    s_addc_u32 s45, s39, 0
    s_mov_b32 s46, 6717440
    s_mov_b32 s47, 0x00020000
    s_add_u32 s52, s38, 8392704
    s_addc_u32 s53, s39, 0
    s_mov_b32 s54, 6291456
    s_mov_b32 s55, 0x00020000
    v_and_b32 v7, 63, v0
    v_lshrrev_b32 v10, 6, v0
    v_and_b32 v8, 15, v0
    v_bfe_u32 v9, v0, 4, 2
    v_and_b32 v11, 1, v10
    v_lshrrev_b32 v12, 1, v10
    v_lshrrev_b32 v1, 1, v9
    v_lshlrev_b32 v1, 4, v1
    v_and_b32 v2, 1, v9
    v_lshl_add_u32 v1, v2, 2, v1
    v_lshrrev_b32 v2, 2, v8
    v_add_u32 v1, v1, v2
    v_mul_u32_u24 v1, 192, v1
    v_and_b32 v2, 3, v8
    v_lshl_add_u32 v1, v2, 3, v1
    v_mul_u32_u24 v2, 3, v12
    v_add_u32 v2, 0, v2
    v_and_b32 v3, 1, v9
    v_xor_b32 v2, v2, v3
    v_lshl_add_u32 v13, v2, 5, v1
    v_mul_u32_u24 v2, 3, v12
    v_add_u32 v2, 1, v2
    v_and_b32 v3, 1, v9
    v_xor_b32 v2, v2, v3
    v_lshl_add_u32 v14, v2, 5, v1
    v_mul_u32_u24 v2, 3, v12
    v_add_u32 v2, 2, v2
    v_and_b32 v3, 1, v9
    v_xor_b32 v2, v2, v3
    v_lshl_add_u32 v15, v2, 5, v1
    v_mul_u32_u24 v1, 8192, v11
    v_lshl_add_u32 v1, v7, 4, v1
    v_mov_b32 v16, v1
    v_mul_u32_u24 v1, 64, v11
    v_add_u32 v1, v1, v8
    v_bfe_u32 v2, v1, 1, 3
    v_mul_u32_u24 v1, 128, v1
    v_add_u32 v13, 20480, v13
    v_add_u32 v14, 20480, v14
    v_add_u32 v15, 20480, v15
    v_add_u32 v16, 20480, v16
    v_mov_b32 v100, 0
    v_mov_b32 v101, 0
    v_mov_b32 v102, 0
    v_mov_b32 v103, 0
    v_mov_b32 v104, 0
    v_mov_b32 v105, 0
    v_mov_b32 v106, 0
    v_mov_b32 v107, 0
    v_mov_b32 v108, 0
    v_mov_b32 v109, 0
    v_mov_b32 v110, 0
    v_mov_b32 v111, 0
    v_mov_b32 v112, 0
    v_mov_b32 v113, 0
    v_mov_b32 v114, 0
    v_mov_b32 v115, 0
    v_mov_b32 v116, 0
    v_mov_b32 v117, 0
    v_mov_b32 v118, 0
    v_mov_b32 v119, 0
    v_mov_b32 v120, 0
    v_mov_b32 v121, 0
    v_mov_b32 v122, 0
    v_mov_b32 v123, 0
    v_mov_b32 v124, 0
    v_mov_b32 v125, 0
    v_mov_b32 v126, 0
    v_mov_b32 v127, 0
    v_mov_b32 v128, 0
    v_mov_b32 v129, 0
    v_mov_b32 v130, 0
    v_mov_b32 v131, 0
    v_mov_b32 v132, 0
    v_mov_b32 v133, 0
    v_mov_b32 v134, 0
    v_mov_b32 v135, 0
    v_mov_b32 v136, 0
    v_mov_b32 v137, 0
    v_mov_b32 v138, 0
    v_mov_b32 v139, 0
    v_mov_b32 v140, 0
    v_mov_b32 v141, 0
    v_mov_b32 v142, 0
    v_mov_b32 v143, 0
    v_mov_b32 v144, 0
    v_mov_b32 v145, 0
    v_mov_b32 v146, 0
    v_mov_b32 v147, 0
    v_mov_b32 v148, 0
    v_mov_b32 v149, 0
    v_mov_b32 v150, 0
    v_mov_b32 v151, 0
    v_mov_b32 v152, 0
    v_mov_b32 v153, 0
    v_mov_b32 v154, 0
    v_mov_b32 v155, 0
    v_mov_b32 v156, 0
    v_mov_b32 v157, 0
    v_mov_b32 v158, 0
    v_mov_b32 v159, 0
    v_mov_b32 v160, 0
    v_mov_b32 v161, 0
    v_mov_b32 v162, 0
    v_mov_b32 v163, 0
    v_mov_b32 v164, 0
    v_mov_b32 v165, 0
    v_mov_b32 v166, 0
    v_mov_b32 v167, 0
    v_mov_b32 v168, 0
    v_mov_b32 v169, 0
    v_mov_b32 v170, 0
    v_mov_b32 v171, 0
    v_mov_b32 v172, 0
    v_mov_b32 v173, 0
    v_mov_b32 v174, 0
    v_mov_b32 v175, 0
    v_mov_b32 v176, 0
    v_mov_b32 v177, 0
    v_mov_b32 v178, 0
    v_mov_b32 v179, 0
    v_mov_b32 v180, 0
    v_mov_b32 v181, 0
    v_mov_b32 v182, 0
    v_mov_b32 v183, 0
    v_mov_b32 v184, 0
    v_mov_b32 v185, 0
    v_mov_b32 v186, 0
    v_mov_b32 v187, 0
    v_mov_b32 v188, 0
    v_mov_b32 v189, 0
    v_mov_b32 v190, 0
    v_mov_b32 v191, 0
    v_mov_b32 v192, 0
    v_mov_b32 v193, 0
    v_mov_b32 v194, 0
    v_mov_b32 v195, 0
    v_lshl_add_u32 v196, v11, 6, v8
    v_lshlrev_b32 v199, 4, v196
    v_add_u32 v199, 159744, v199
    v_add_u32 v196, s68, v196
    v_mul_u32_u24 v2, 48, v12
    v_lshl_add_u32 v3, v9, 2, v2
    v_lshlrev_b32 v200, 2, v3
    v_add_u32 v200, 161792, v200
    v_and_b32 v1, 0xfff0, v196
    v_mul_u32_u24 v1, 3072, v1
    v_lshl_add_u32 v1, v8, 4, v1
    v_lshl_add_u32 v1, v2, 5, v1
    s_lshl_b32 s71, s69, 4
    v_add_u32 v1, s71, v1
    v_lshrrev_b32 v2, 1, v9
    v_lshl_add_u32 v1, v2, 8, v1
    v_and_b32 v2, 1, v9
    v_lshl_add_u32 v197, v2, 9, v1
    v_mul_u32_u24 v2, 49152, v2
    v_add_u32 v198, v2, v1
    s_cmp_lg_u32 s67, 0
    s_cbranch_scc1 aw_22
    s_mov_b64 exec, 1
    v_mov_b32 v1, 0
    s_lshr_b32 s71, s68, 7
    s_lshl_b32 s71, s71, 8
    s_add_u32 s71, s71, 0
    s_mov_b32 s65, 0x20000
aw_21:
    s_and_b32 s72, s65, 7
    s_cmp_eq_u32 s72, 1
    s_cbranch_scc1 aw_23
    v_mov_b32 v2, 0
    buffer_atomic_add v2, v1, s[8:11], s71 offen offset:128 sc0
    s_branch aw_24
aw_23:
    s_cmp_eq_u32 s15, 0
    s_cbranch_scc1 df_25
    s_sub_u32 s15, s15, 1
    v_mov_b32 v243, 1
    buffer_atomic_add v243, v1, s[8:11], s15 offen sc1
    s_mov_b32 s15, 0
df_25:
    buffer_load_dword v2, v1, s[8:11], s71 offen sc1
aw_24:
    s_sub_u32 s65, s65, 1
    s_waitcnt vmcnt(0)
    v_readfirstlane_b32 s72, v2
    s_cmp_eq_u32 s65, 0
    s_cselect_b32 s66, 16, 0
    s_max_u32 s72, s72, s66
    s_cmp_lt_u32 s72, 16
    s_cbranch_scc1 aw_21
    s_cmp_eq_u32 s15, 0
    s_cbranch_scc1 df_26
    s_sub_u32 s15, s15, 1
    v_mov_b32 v243, 1
    buffer_atomic_add v243, v1, s[8:11], s15 offen sc1
    s_mov_b32 s15, 0
df_26:
    s_mov_b64 exec, -1
aw_22:
    s_barrier
    s_mov_b32 s76, 10
    s_mov_b32 s77, 0
    s_barrier
    ds_read_b128 v[68:71], v16 offset:0
    ds_read_b128 v[72:75], v16 offset:2048
    ds_read_b128 v[76:79], v16 offset:4096
    ds_read_b128 v[80:83], v16 offset:6144
    ds_read_b64_tr_b16 v[20:21], v13 offset:16384
    ds_read_b64_tr_b16 v[22:23], v13 offset:17920
    ds_read_b64_tr_b16 v[24:25], v14 offset:16384
    ds_read_b64_tr_b16 v[26:27], v14 offset:17920
    ds_read_b64_tr_b16 v[28:29], v15 offset:16384
    ds_read_b64_tr_b16 v[30:31], v15 offset:17920
    ds_read_b64_tr_b16 v[32:33], v13 offset:28672
    ds_read_b64_tr_b16 v[34:35], v13 offset:30208
    ds_read_b64_tr_b16 v[36:37], v14 offset:28672
    ds_read_b64_tr_b16 v[38:39], v14 offset:30208
    ds_read_b64_tr_b16 v[40:41], v15 offset:28672
    ds_read_b64_tr_b16 v[42:43], v15 offset:30208
k4_loop:
    s_waitcnt lgkmcnt(0)
    v_mfma_f32_16x16x32_bf16 v[100:103], v[20:23], v[68:71], v[100:103]
    ds_read_b128 v[84:87], v16 offset:1024
    v_mfma_f32_16x16x32_bf16 v[124:127], v[20:23], v[72:75], v[124:127]
    ds_read_b128 v[88:91], v16 offset:3072
    v_mfma_f32_16x16x32_bf16 v[148:151], v[20:23], v[76:79], v[148:151]
    ds_read_b128 v[92:95], v16 offset:5120
    v_mfma_f32_16x16x32_bf16 v[172:175], v[20:23], v[80:83], v[172:175]
    ds_read_b128 v[96:99], v16 offset:7168
    v_mfma_f32_16x16x32_bf16 v[104:107], v[24:27], v[68:71], v[104:107]
    ds_read_b64_tr_b16 v[44:45], v13 offset:22528
    v_mfma_f32_16x16x32_bf16 v[128:131], v[24:27], v[72:75], v[128:131]
    ds_read_b64_tr_b16 v[46:47], v13 offset:24064
    v_mfma_f32_16x16x32_bf16 v[152:155], v[24:27], v[76:79], v[152:155]
    ds_read_b64_tr_b16 v[48:49], v14 offset:22528
    v_mfma_f32_16x16x32_bf16 v[176:179], v[24:27], v[80:83], v[176:179]
    ds_read_b64_tr_b16 v[50:51], v14 offset:24064
    v_mfma_f32_16x16x32_bf16 v[108:111], v[28:31], v[68:71], v[108:111]
    ds_read_b64_tr_b16 v[52:53], v15 offset:22528
    v_mfma_f32_16x16x32_bf16 v[132:135], v[28:31], v[72:75], v[132:135]
    ds_read_b64_tr_b16 v[54:55], v15 offset:24064
    v_mfma_f32_16x16x32_bf16 v[156:159], v[28:31], v[76:79], v[156:159]
    ds_read_b64_tr_b16 v[56:57], v13 offset:34816
    v_mfma_f32_16x16x32_bf16 v[180:183], v[28:31], v[80:83], v[180:183]
    ds_read_b64_tr_b16 v[58:59], v13 offset:36352
    v_mfma_f32_16x16x32_bf16 v[112:115], v[32:35], v[68:71], v[112:115]
    ds_read_b64_tr_b16 v[60:61], v14 offset:34816
    v_mfma_f32_16x16x32_bf16 v[136:139], v[32:35], v[72:75], v[136:139]
    ds_read_b64_tr_b16 v[62:63], v14 offset:36352
    v_mfma_f32_16x16x32_bf16 v[160:163], v[32:35], v[76:79], v[160:163]
    ds_read_b64_tr_b16 v[64:65], v15 offset:34816
    v_mfma_f32_16x16x32_bf16 v[184:187], v[32:35], v[80:83], v[184:187]
    ds_read_b64_tr_b16 v[66:67], v15 offset:36352
    v_mfma_f32_16x16x32_bf16 v[116:119], v[36:39], v[68:71], v[116:119]
    s_mov_b32 s79, s77
    s_add_u32 s77, s77, 40960
    v_mfma_f32_16x16x32_bf16 v[140:143], v[36:39], v[72:75], v[140:143]
    s_cmp_ge_u32 s77, 122880
    s_cselect_b32 s77, 0, s77
    s_sub_u32 s79, s77, s79
    v_mfma_f32_16x16x32_bf16 v[164:167], v[36:39], v[76:79], v[164:167]
    v_add_u32 v13, s79, v13
    v_mfma_f32_16x16x32_bf16 v[188:191], v[36:39], v[80:83], v[188:191]
    v_add_u32 v14, s79, v14
    v_mfma_f32_16x16x32_bf16 v[120:123], v[40:43], v[68:71], v[120:123]
    v_add_u32 v15, s79, v15
    v_mfma_f32_16x16x32_bf16 v[144:147], v[40:43], v[72:75], v[144:147]
    v_add_u32 v16, s79, v16
    v_mfma_f32_16x16x32_bf16 v[168:171], v[40:43], v[76:79], v[168:171]
    v_mfma_f32_16x16x32_bf16 v[192:195], v[40:43], v[80:83], v[192:195]
    s_waitcnt lgkmcnt(0)
    v_mfma_f32_16x16x32_bf16 v[100:103], v[44:47], v[84:87], v[100:103]
    s_barrier
    v_mfma_f32_16x16x32_bf16 v[124:127], v[44:47], v[88:91], v[124:127]
    ds_read_b128 v[68:71], v16 offset:0
    v_mfma_f32_16x16x32_bf16 v[148:151], v[44:47], v[92:95], v[148:151]
    ds_read_b128 v[72:75], v16 offset:2048
    v_mfma_f32_16x16x32_bf16 v[172:175], v[44:47], v[96:99], v[172:175]
    ds_read_b128 v[76:79], v16 offset:4096
    v_mfma_f32_16x16x32_bf16 v[104:107], v[48:51], v[84:87], v[104:107]
    ds_read_b128 v[80:83], v16 offset:6144
    v_mfma_f32_16x16x32_bf16 v[128:131], v[48:51], v[88:91], v[128:131]
    ds_read_b64_tr_b16 v[20:21], v13 offset:16384
    v_mfma_f32_16x16x32_bf16 v[152:155], v[48:51], v[92:95], v[152:155]
    ds_read_b64_tr_b16 v[22:23], v13 offset:17920
    v_mfma_f32_16x16x32_bf16 v[176:179], v[48:51], v[96:99], v[176:179]
    ds_read_b64_tr_b16 v[24:25], v14 offset:16384
    v_mfma_f32_16x16x32_bf16 v[108:111], v[52:55], v[84:87], v[108:111]
    ds_read_b64_tr_b16 v[26:27], v14 offset:17920
    v_mfma_f32_16x16x32_bf16 v[132:135], v[52:55], v[88:91], v[132:135]
    ds_read_b64_tr_b16 v[28:29], v15 offset:16384
    v_mfma_f32_16x16x32_bf16 v[156:159], v[52:55], v[92:95], v[156:159]
    ds_read_b64_tr_b16 v[30:31], v15 offset:17920
    v_mfma_f32_16x16x32_bf16 v[180:183], v[52:55], v[96:99], v[180:183]
    ds_read_b64_tr_b16 v[32:33], v13 offset:28672
    v_mfma_f32_16x16x32_bf16 v[112:115], v[56:59], v[84:87], v[112:115]
    ds_read_b64_tr_b16 v[34:35], v13 offset:30208
    v_mfma_f32_16x16x32_bf16 v[136:139], v[56:59], v[88:91], v[136:139]
    ds_read_b64_tr_b16 v[36:37], v14 offset:28672
    v_mfma_f32_16x16x32_bf16 v[160:163], v[56:59], v[92:95], v[160:163]
    ds_read_b64_tr_b16 v[38:39], v14 offset:30208
    v_mfma_f32_16x16x32_bf16 v[184:187], v[56:59], v[96:99], v[184:187]
    ds_read_b64_tr_b16 v[40:41], v15 offset:28672
    v_mfma_f32_16x16x32_bf16 v[116:119], v[60:63], v[84:87], v[116:119]
    ds_read_b64_tr_b16 v[42:43], v15 offset:30208
    v_mfma_f32_16x16x32_bf16 v[140:143], v[60:63], v[88:91], v[140:143]
    s_sub_u32 s76, s76, 1
    s_cmp_lg_u32 s76, 0
    v_mfma_f32_16x16x32_bf16 v[164:167], v[60:63], v[92:95], v[164:167]
    v_mfma_f32_16x16x32_bf16 v[188:191], v[60:63], v[96:99], v[188:191]
    v_mfma_f32_16x16x32_bf16 v[120:123], v[64:67], v[84:87], v[120:123]
    v_mfma_f32_16x16x32_bf16 v[144:147], v[64:67], v[88:91], v[144:147]
    v_mfma_f32_16x16x32_bf16 v[168:171], v[64:67], v[92:95], v[168:171]
    v_mfma_f32_16x16x32_bf16 v[192:195], v[64:67], v[96:99], v[192:195]
    s_cbranch_scc1 k4_loop
    s_waitcnt vmcnt(0) lgkmcnt(0)
    ds_read_b128 v[20:23], v199 offset:0
    ds_read_b128 v[24:27], v199 offset:256
    ds_read_b128 v[28:31], v199 offset:512
    ds_read_b128 v[32:35], v199 offset:768
    ds_read_b128 v[44:47], v200 offset:0
    ds_read_b128 v[48:51], v200 offset:64
    ds_read_b128 v[52:55], v200 offset:128
    ds_read_b128 v[56:59], v200 offset:384
    ds_read_b128 v[60:63], v200 offset:448
    ds_read_b128 v[64:67], v200 offset:512
    s_waitcnt lgkmcnt(0)
    v_pk_fma_f32 v[100:101], v[20:21], v[44:45], v[100:101] op_sel_hi:[0,1,1]
    v_pk_fma_f32 v[112:113], v[20:21], v[56:57], v[112:113] op_sel_hi:[0,1,1]
    v_pk_fma_f32 v[102:103], v[20:21], v[46:47], v[102:103] op_sel_hi:[0,1,1]
    v_pk_fma_f32 v[114:115], v[20:21], v[58:59], v[114:115] op_sel_hi:[0,1,1]
    v_pk_mul_f32 v[68:69], v[100:101], v[100:101]
    v_pk_mul_f32 v[112:113], v[112:113], v[100:101]
    v_pk_mul_f32 v[70:71], v[102:103], v[102:103]
    v_pk_mul_f32 v[114:115], v[114:115], v[102:103]
    v_pk_fma_f32 v[68:69], v[68:69], v[22:23], v[20:21] op_sel:[0,0,1] op_sel_hi:[1,0,1]
    v_pk_fma_f32 v[70:71], v[70:71], v[22:23], v[20:21] op_sel:[0,0,1] op_sel_hi:[1,0,1]
    v_pk_mul_f32 v[68:69], v[68:69], v[100:101]
    v_pk_mul_f32 v[70:71], v[70:71], v[102:103]
    v_exp_f32 v68, v68
    v_exp_f32 v69, v69
    v_exp_f32 v70, v70
    v_exp_f32 v71, v71
    v_pk_fma_f32 v[68:69], v[68:69], v[22:23], v[22:23] op_sel:[0,1,1] op_sel_hi:[1,1,1]
    v_pk_fma_f32 v[70:71], v[70:71], v[22:23], v[22:23] op_sel:[0,1,1] op_sel_hi:[1,1,1]
    v_rcp_f32 v68, v68
    v_rcp_f32 v69, v69
    v_rcp_f32 v70, v70
    v_rcp_f32 v71, v71
    s_nop 0
    v_pk_mul_f32 v[112:113], v[112:113], v[68:69]
    v_pk_mul_f32 v[114:115], v[114:115], v[70:71]
    v_cvt_pk_bf16_f32 v112, v112, v113
    v_cvt_pk_bf16_f32 v113, v114, v115
    v_pk_fma_f32 v[104:105], v[20:21], v[48:49], v[104:105] op_sel_hi:[0,1,1]
    v_pk_fma_f32 v[116:117], v[20:21], v[60:61], v[116:117] op_sel_hi:[0,1,1]
    v_pk_fma_f32 v[106:107], v[20:21], v[50:51], v[106:107] op_sel_hi:[0,1,1]
    v_pk_fma_f32 v[118:119], v[20:21], v[62:63], v[118:119] op_sel_hi:[0,1,1]
    v_pk_mul_f32 v[76:77], v[104:105], v[104:105]
    v_pk_mul_f32 v[116:117], v[116:117], v[104:105]
    v_pk_mul_f32 v[78:79], v[106:107], v[106:107]
    v_pk_mul_f32 v[118:119], v[118:119], v[106:107]
    v_pk_fma_f32 v[76:77], v[76:77], v[22:23], v[20:21] op_sel:[0,0,1] op_sel_hi:[1,0,1]
    v_pk_fma_f32 v[78:79], v[78:79], v[22:23], v[20:21] op_sel:[0,0,1] op_sel_hi:[1,0,1]
    v_pk_mul_f32 v[76:77], v[76:77], v[104:105]
    v_pk_mul_f32 v[78:79], v[78:79], v[106:107]
    v_exp_f32 v76, v76
    v_exp_f32 v77, v77
    v_exp_f32 v78, v78
    v_exp_f32 v79, v79
    v_pk_fma_f32 v[76:77], v[76:77], v[22:23], v[22:23] op_sel:[0,1,1] op_sel_hi:[1,1,1]
    v_pk_fma_f32 v[78:79], v[78:79], v[22:23], v[22:23] op_sel:[0,1,1] op_sel_hi:[1,1,1]
    v_rcp_f32 v76, v76
    v_rcp_f32 v77, v77
    v_rcp_f32 v78, v78
    v_rcp_f32 v79, v79
    s_nop 0
    v_pk_mul_f32 v[116:117], v[116:117], v[76:77]
    v_pk_mul_f32 v[118:119], v[118:119], v[78:79]
    v_cvt_pk_bf16_f32 v114, v116, v117
    v_cvt_pk_bf16_f32 v115, v118, v119
    s_mov_b32 s66, 0
    s_nop 0
    v_permlane16_swap_b32 v112, v114
    v_permlane16_swap_b32 v113, v115
    buffer_store_dwordx4 v[112:115], v197, s[52:55], s66 offen sc1
    v_pk_fma_f32 v[108:109], v[20:21], v[52:53], v[108:109] op_sel_hi:[0,1,1]
    v_pk_fma_f32 v[120:121], v[20:21], v[64:65], v[120:121] op_sel_hi:[0,1,1]
    v_pk_fma_f32 v[110:111], v[20:21], v[54:55], v[110:111] op_sel_hi:[0,1,1]
    v_pk_fma_f32 v[122:123], v[20:21], v[66:67], v[122:123] op_sel_hi:[0,1,1]
    v_pk_mul_f32 v[68:69], v[108:109], v[108:109]
    v_pk_mul_f32 v[120:121], v[120:121], v[108:109]
    v_pk_mul_f32 v[70:71], v[110:111], v[110:111]
    v_pk_mul_f32 v[122:123], v[122:123], v[110:111]
    v_pk_fma_f32 v[68:69], v[68:69], v[22:23], v[20:21] op_sel:[0,0,1] op_sel_hi:[1,0,1]
    v_pk_fma_f32 v[70:71], v[70:71], v[22:23], v[20:21] op_sel:[0,0,1] op_sel_hi:[1,0,1]
    v_pk_mul_f32 v[68:69], v[68:69], v[108:109]
    v_pk_mul_f32 v[70:71], v[70:71], v[110:111]
    v_exp_f32 v68, v68
    v_exp_f32 v69, v69
    v_exp_f32 v70, v70
    v_exp_f32 v71, v71
    v_pk_fma_f32 v[68:69], v[68:69], v[22:23], v[22:23] op_sel:[0,1,1] op_sel_hi:[1,1,1]
    v_pk_fma_f32 v[70:71], v[70:71], v[22:23], v[22:23] op_sel:[0,1,1] op_sel_hi:[1,1,1]
    v_rcp_f32 v68, v68
    v_rcp_f32 v69, v69
    v_rcp_f32 v70, v70
    v_rcp_f32 v71, v71
    s_nop 0
    v_pk_mul_f32 v[120:121], v[120:121], v[68:69]
    v_pk_mul_f32 v[122:123], v[122:123], v[70:71]
    v_cvt_pk_bf16_f32 v120, v120, v121
    v_cvt_pk_bf16_f32 v121, v122, v123
    v_pk_fma_f32 v[124:125], v[24:25], v[44:45], v[124:125] op_sel_hi:[0,1,1]
    v_pk_fma_f32 v[136:137], v[24:25], v[56:57], v[136:137] op_sel_hi:[0,1,1]
    v_pk_fma_f32 v[126:127], v[24:25], v[46:47], v[126:127] op_sel_hi:[0,1,1]
    v_pk_fma_f32 v[138:139], v[24:25], v[58:59], v[138:139] op_sel_hi:[0,1,1]
    v_pk_mul_f32 v[68:69], v[124:125], v[124:125]
    v_pk_mul_f32 v[136:137], v[136:137], v[124:125]
    v_pk_mul_f32 v[70:71], v[126:127], v[126:127]
    v_pk_mul_f32 v[138:139], v[138:139], v[126:127]
    v_pk_fma_f32 v[68:69], v[68:69], v[26:27], v[24:25] op_sel:[0,0,1] op_sel_hi:[1,0,1]
    v_pk_fma_f32 v[70:71], v[70:71], v[26:27], v[24:25] op_sel:[0,0,1] op_sel_hi:[1,0,1]
    v_pk_mul_f32 v[68:69], v[68:69], v[124:125]
    v_pk_mul_f32 v[70:71], v[70:71], v[126:127]
    v_exp_f32 v68, v68
    v_exp_f32 v69, v69
    v_exp_f32 v70, v70
    v_exp_f32 v71, v71
    v_pk_fma_f32 v[68:69], v[68:69], v[26:27], v[26:27] op_sel:[0,1,1] op_sel_hi:[1,1,1]
    v_pk_fma_f32 v[70:71], v[70:71], v[26:27], v[26:27] op_sel:[0,1,1] op_sel_hi:[1,1,1]
    v_rcp_f32 v68, v68
    v_rcp_f32 v69, v69
    v_rcp_f32 v70, v70
    v_rcp_f32 v71, v71
    s_nop 0
    v_pk_mul_f32 v[136:137], v[136:137], v[68:69]
    v_pk_mul_f32 v[138:139], v[138:139], v[70:71]
    v_cvt_pk_bf16_f32 v136, v136, v137
    v_cvt_pk_bf16_f32 v137, v138, v139
    v_pk_fma_f32 v[128:129], v[24:25], v[48:49], v[128:129] op_sel_hi:[0,1,1]
    v_pk_fma_f32 v[140:141], v[24:25], v[60:61], v[140:141] op_sel_hi:[0,1,1]
    v_pk_fma_f32 v[130:131], v[24:25], v[50:51], v[130:131] op_sel_hi:[0,1,1]
    v_pk_fma_f32 v[142:143], v[24:25], v[62:63], v[142:143] op_sel_hi:[0,1,1]
    v_pk_mul_f32 v[76:77], v[128:129], v[128:129]
    v_pk_mul_f32 v[140:141], v[140:141], v[128:129]
    v_pk_mul_f32 v[78:79], v[130:131], v[130:131]
    v_pk_mul_f32 v[142:143], v[142:143], v[130:131]
    v_pk_fma_f32 v[76:77], v[76:77], v[26:27], v[24:25] op_sel:[0,0,1] op_sel_hi:[1,0,1]
    v_pk_fma_f32 v[78:79], v[78:79], v[26:27], v[24:25] op_sel:[0,0,1] op_sel_hi:[1,0,1]
    v_pk_mul_f32 v[76:77], v[76:77], v[128:129]
    v_pk_mul_f32 v[78:79], v[78:79], v[130:131]
    v_exp_f32 v76, v76
    v_exp_f32 v77, v77
    v_exp_f32 v78, v78
    v_exp_f32 v79, v79
    v_pk_fma_f32 v[76:77], v[76:77], v[26:27], v[26:27] op_sel:[0,1,1] op_sel_hi:[1,1,1]
    v_pk_fma_f32 v[78:79], v[78:79], v[26:27], v[26:27] op_sel:[0,1,1] op_sel_hi:[1,1,1]
    v_rcp_f32 v76, v76
    v_rcp_f32 v77, v77
    v_rcp_f32 v78, v78
    v_rcp_f32 v79, v79
    s_nop 0
    v_pk_mul_f32 v[140:141], v[140:141], v[76:77]
    v_pk_mul_f32 v[142:143], v[142:143], v[78:79]
    v_cvt_pk_bf16_f32 v138, v140, v141
    v_cvt_pk_bf16_f32 v139, v142, v143
    s_mov_b32 s66, 49152
    s_nop 0
    v_permlane16_swap_b32 v136, v138
    v_permlane16_swap_b32 v137, v139
    buffer_store_dwordx4 v[136:139], v197, s[52:55], s66 offen sc1
    v_pk_fma_f32 v[132:133], v[24:25], v[52:53], v[132:133] op_sel_hi:[0,1,1]
    v_pk_fma_f32 v[144:145], v[24:25], v[64:65], v[144:145] op_sel_hi:[0,1,1]
    v_pk_fma_f32 v[134:135], v[24:25], v[54:55], v[134:135] op_sel_hi:[0,1,1]
    v_pk_fma_f32 v[146:147], v[24:25], v[66:67], v[146:147] op_sel_hi:[0,1,1]
    v_pk_mul_f32 v[68:69], v[132:133], v[132:133]
    v_pk_mul_f32 v[144:145], v[144:145], v[132:133]
    v_pk_mul_f32 v[70:71], v[134:135], v[134:135]
    v_pk_mul_f32 v[146:147], v[146:147], v[134:135]
    v_pk_fma_f32 v[68:69], v[68:69], v[26:27], v[24:25] op_sel:[0,0,1] op_sel_hi:[1,0,1]
    v_pk_fma_f32 v[70:71], v[70:71], v[26:27], v[24:25] op_sel:[0,0,1] op_sel_hi:[1,0,1]
    v_pk_mul_f32 v[68:69], v[68:69], v[132:133]
    v_pk_mul_f32 v[70:71], v[70:71], v[134:135]
    v_exp_f32 v68, v68
    v_exp_f32 v69, v69
    v_exp_f32 v70, v70
    v_exp_f32 v71, v71
    v_pk_fma_f32 v[68:69], v[68:69], v[26:27], v[26:27] op_sel:[0,1,1] op_sel_hi:[1,1,1]
    v_pk_fma_f32 v[70:71], v[70:71], v[26:27], v[26:27] op_sel:[0,1,1] op_sel_hi:[1,1,1]
    v_rcp_f32 v68, v68
    v_rcp_f32 v69, v69
    v_rcp_f32 v70, v70
    v_rcp_f32 v71, v71
    s_nop 0
    v_pk_mul_f32 v[144:145], v[144:145], v[68:69]
    v_pk_mul_f32 v[146:147], v[146:147], v[70:71]
    v_cvt_pk_bf16_f32 v122, v144, v145
    v_cvt_pk_bf16_f32 v123, v146, v147
    s_mov_b32 s66, 0
    s_nop 0
    v_permlane16_swap_b32 v120, v122
    v_permlane16_swap_b32 v121, v123
    buffer_store_dwordx4 v[120:123], v198, s[52:55], s66 offen offset:1024 sc1
    v_pk_fma_f32 v[148:149], v[28:29], v[44:45], v[148:149] op_sel_hi:[0,1,1]
    v_pk_fma_f32 v[160:161], v[28:29], v[56:57], v[160:161] op_sel_hi:[0,1,1]
    v_pk_fma_f32 v[150:151], v[28:29], v[46:47], v[150:151] op_sel_hi:[0,1,1]
    v_pk_fma_f32 v[162:163], v[28:29], v[58:59], v[162:163] op_sel_hi:[0,1,1]
    v_pk_mul_f32 v[68:69], v[148:149], v[148:149]
    v_pk_mul_f32 v[160:161], v[160:161], v[148:149]
    v_pk_mul_f32 v[70:71], v[150:151], v[150:151]
    v_pk_mul_f32 v[162:163], v[162:163], v[150:151]
    v_pk_fma_f32 v[68:69], v[68:69], v[30:31], v[28:29] op_sel:[0,0,1] op_sel_hi:[1,0,1]
    v_pk_fma_f32 v[70:71], v[70:71], v[30:31], v[28:29] op_sel:[0,0,1] op_sel_hi:[1,0,1]
    v_pk_mul_f32 v[68:69], v[68:69], v[148:149]
    v_pk_mul_f32 v[70:71], v[70:71], v[150:151]
    v_exp_f32 v68, v68
    v_exp_f32 v69, v69
    v_exp_f32 v70, v70
    v_exp_f32 v71, v71
    v_pk_fma_f32 v[68:69], v[68:69], v[30:31], v[30:31] op_sel:[0,1,1] op_sel_hi:[1,1,1]
    v_pk_fma_f32 v[70:71], v[70:71], v[30:31], v[30:31] op_sel:[0,1,1] op_sel_hi:[1,1,1]
    v_rcp_f32 v68, v68
    v_rcp_f32 v69, v69
    v_rcp_f32 v70, v70
    v_rcp_f32 v71, v71
    s_nop 0
    v_pk_mul_f32 v[160:161], v[160:161], v[68:69]
    v_pk_mul_f32 v[162:163], v[162:163], v[70:71]
    v_cvt_pk_bf16_f32 v160, v160, v161
    v_cvt_pk_bf16_f32 v161, v162, v163
    v_pk_fma_f32 v[152:153], v[28:29], v[48:49], v[152:153] op_sel_hi:[0,1,1]
    v_pk_fma_f32 v[164:165], v[28:29], v[60:61], v[164:165] op_sel_hi:[0,1,1]
    v_pk_fma_f32 v[154:155], v[28:29], v[50:51], v[154:155] op_sel_hi:[0,1,1]
    v_pk_fma_f32 v[166:167], v[28:29], v[62:63], v[166:167] op_sel_hi:[0,1,1]
    v_pk_mul_f32 v[76:77], v[152:153], v[152:153]
    v_pk_mul_f32 v[164:165], v[164:165], v[152:153]
    v_pk_mul_f32 v[78:79], v[154:155], v[154:155]
    v_pk_mul_f32 v[166:167], v[166:167], v[154:155]
    v_pk_fma_f32 v[76:77], v[76:77], v[30:31], v[28:29] op_sel:[0,0,1] op_sel_hi:[1,0,1]
    v_pk_fma_f32 v[78:79], v[78:79], v[30:31], v[28:29] op_sel:[0,0,1] op_sel_hi:[1,0,1]
    v_pk_mul_f32 v[76:77], v[76:77], v[152:153]
    v_pk_mul_f32 v[78:79], v[78:79], v[154:155]
    v_exp_f32 v76, v76
    v_exp_f32 v77, v77
    v_exp_f32 v78, v78
    v_exp_f32 v79, v79
    v_pk_fma_f32 v[76:77], v[76:77], v[30:31], v[30:31] op_sel:[0,1,1] op_sel_hi:[1,1,1]
    v_pk_fma_f32 v[78:79], v[78:79], v[30:31], v[30:31] op_sel:[0,1,1] op_sel_hi:[1,1,1]
    v_rcp_f32 v76, v76
    v_rcp_f32 v77, v77
    v_rcp_f32 v78, v78
    v_rcp_f32 v79, v79
    s_nop 0
    v_pk_mul_f32 v[164:165], v[164:165], v[76:77]
    v_pk_mul_f32 v[166:167], v[166:167], v[78:79]
    v_cvt_pk_bf16_f32 v162, v164, v165
    v_cvt_pk_bf16_f32 v163, v166, v167
    s_mov_b32 s66, 98304
    s_nop 0
    v_permlane16_swap_b32 v160, v162
    v_permlane16_swap_b32 v161, v163
    buffer_store_dwordx4 v[160:163], v197, s[52:55], s66 offen sc1
    v_pk_fma_f32 v[156:157], v[28:29], v[52:53], v[156:157] op_sel_hi:[0,1,1]
    v_pk_fma_f32 v[168:169], v[28:29], v[64:65], v[168:169] op_sel_hi:[0,1,1]
    v_pk_fma_f32 v[158:159], v[28:29], v[54:55], v[158:159] op_sel_hi:[0,1,1]
    v_pk_fma_f32 v[170:171], v[28:29], v[66:67], v[170:171] op_sel_hi:[0,1,1]
    v_pk_mul_f32 v[68:69], v[156:157], v[156:157]
    v_pk_mul_f32 v[168:169], v[168:169], v[156:157]
    v_pk_mul_f32 v[70:71], v[158:159], v[158:159]
    v_pk_mul_f32 v[170:171], v[170:171], v[158:159]
    v_pk_fma_f32 v[68:69], v[68:69], v[30:31], v[28:29] op_sel:[0,0,1] op_sel_hi:[1,0,1]
    v_pk_fma_f32 v[70:71], v[70:71], v[30:31], v[28:29] op_sel:[0,0,1] op_sel_hi:[1,0,1]
    v_pk_mul_f32 v[68:69], v[68:69], v[156:157]
    v_pk_mul_f32 v[70:71], v[70:71], v[158:159]
    v_exp_f32 v68, v68
    v_exp_f32 v69, v69
    v_exp_f32 v70, v70
    v_exp_f32 v71, v71
    v_pk_fma_f32 v[68:69], v[68:69], v[30:31], v[30:31] op_sel:[0,1,1] op_sel_hi:[1,1,1]
    v_pk_fma_f32 v[70:71], v[70:71], v[30:31], v[30:31] op_sel:[0,1,1] op_sel_hi:[1,1,1]
    v_rcp_f32 v68, v68
    v_rcp_f32 v69, v69
    v_rcp_f32 v70, v70
    v_rcp_f32 v71, v71
    s_nop 0
    v_pk_mul_f32 v[168:169], v[168:169], v[68:69]
    v_pk_mul_f32 v[170:171], v[170:171], v[70:71]
    v_cvt_pk_bf16_f32 v168, v168, v169
    v_cvt_pk_bf16_f32 v169, v170, v171
    v_pk_fma_f32 v[172:173], v[32:33], v[44:45], v[172:173] op_sel_hi:[0,1,1]
    v_pk_fma_f32 v[184:185], v[32:33], v[56:57], v[184:185] op_sel_hi:[0,1,1]
    v_pk_fma_f32 v[174:175], v[32:33], v[46:47], v[174:175] op_sel_hi:[0,1,1]
    v_pk_fma_f32 v[186:187], v[32:33], v[58:59], v[186:187] op_sel_hi:[0,1,1]
    v_pk_mul_f32 v[68:69], v[172:173], v[172:173]
    v_pk_mul_f32 v[184:185], v[184:185], v[172:173]
    v_pk_mul_f32 v[70:71], v[174:175], v[174:175]
    v_pk_mul_f32 v[186:187], v[186:187], v[174:175]
    v_pk_fma_f32 v[68:69], v[68:69], v[34:35], v[32:33] op_sel:[0,0,1] op_sel_hi:[1,0,1]
    v_pk_fma_f32 v[70:71], v[70:71], v[34:35], v[32:33] op_sel:[0,0,1] op_sel_hi:[1,0,1]
    v_pk_mul_f32 v[68:69], v[68:69], v[172:173]
    v_pk_mul_f32 v[70:71], v[70:71], v[174:175]
    v_exp_f32 v68, v68
    v_exp_f32 v69, v69
    v_exp_f32 v70, v70
    v_exp_f32 v71, v71
    v_pk_fma_f32 v[68:69], v[68:69], v[34:35], v[34:35] op_sel:[0,1,1] op_sel_hi:[1,1,1]
    v_pk_fma_f32 v[70:71], v[70:71], v[34:35], v[34:35] op_sel:[0,1,1] op_sel_hi:[1,1,1]
    v_rcp_f32 v68, v68
    v_rcp_f32 v69, v69
    v_rcp_f32 v70, v70
    v_rcp_f32 v71, v71
    s_nop 0
    v_pk_mul_f32 v[184:185], v[184:185], v[68:69]
    v_pk_mul_f32 v[186:187], v[186:187], v[70:71]
    v_cvt_pk_bf16_f32 v184, v184, v185
    v_cvt_pk_bf16_f32 v185, v186, v187
    v_pk_fma_f32 v[176:177], v[32:33], v[48:49], v[176:177] op_sel_hi:[0,1,1]
    v_pk_fma_f32 v[188:189], v[32:33], v[60:61], v[188:189] op_sel_hi:[0,1,1]
    v_pk_fma_f32 v[178:179], v[32:33], v[50:51], v[178:179] op_sel_hi:[0,1,1]
    v_pk_fma_f32 v[190:191], v[32:33], v[62:63], v[190:191] op_sel_hi:[0,1,1]
    v_pk_mul_f32 v[76:77], v[176:177], v[176:177]
    v_pk_mul_f32 v[188:189], v[188:189], v[176:177]
    v_pk_mul_f32 v[78:79], v[178:179], v[178:179]
    v_pk_mul_f32 v[190:191], v[190:191], v[178:179]
    v_pk_fma_f32 v[76:77], v[76:77], v[34:35], v[32:33] op_sel:[0,0,1] op_sel_hi:[1,0,1]
    v_pk_fma_f32 v[78:79], v[78:79], v[34:35], v[32:33] op_sel:[0,0,1] op_sel_hi:[1,0,1]
    v_pk_mul_f32 v[76:77], v[76:77], v[176:177]
    v_pk_mul_f32 v[78:79], v[78:79], v[178:179]
    v_exp_f32 v76, v76
    v_exp_f32 v77, v77
    v_exp_f32 v78, v78
    v_exp_f32 v79, v79
    v_pk_fma_f32 v[76:77], v[76:77], v[34:35], v[34:35] op_sel:[0,1,1] op_sel_hi:[1,1,1]
    v_pk_fma_f32 v[78:79], v[78:79], v[34:35], v[34:35] op_sel:[0,1,1] op_sel_hi:[1,1,1]
    v_rcp_f32 v76, v76
    v_rcp_f32 v77, v77
    v_rcp_f32 v78, v78
    v_rcp_f32 v79, v79
    s_nop 0
    v_pk_mul_f32 v[188:189], v[188:189], v[76:77]
    v_pk_mul_f32 v[190:191], v[190:191], v[78:79]
    v_cvt_pk_bf16_f32 v186, v188, v189
    v_cvt_pk_bf16_f32 v187, v190, v191
    s_mov_b32 s66, 147456
    s_nop 0
    v_permlane16_swap_b32 v184, v186
    v_permlane16_swap_b32 v185, v187
    buffer_store_dwordx4 v[184:187], v197, s[52:55], s66 offen sc1
    v_pk_fma_f32 v[180:181], v[32:33], v[52:53], v[180:181] op_sel_hi:[0,1,1]
    v_pk_fma_f32 v[192:193], v[32:33], v[64:65], v[192:193] op_sel_hi:[0,1,1]
    v_pk_fma_f32 v[182:183], v[32:33], v[54:55], v[182:183] op_sel_hi:[0,1,1]
    v_pk_fma_f32 v[194:195], v[32:33], v[66:67], v[194:195] op_sel_hi:[0,1,1]
    v_pk_mul_f32 v[68:69], v[180:181], v[180:181]
    v_pk_mul_f32 v[192:193], v[192:193], v[180:181]
    v_pk_mul_f32 v[70:71], v[182:183], v[182:183]
    v_pk_mul_f32 v[194:195], v[194:195], v[182:183]
    v_pk_fma_f32 v[68:69], v[68:69], v[34:35], v[32:33] op_sel:[0,0,1] op_sel_hi:[1,0,1]
    v_pk_fma_f32 v[70:71], v[70:71], v[34:35], v[32:33] op_sel:[0,0,1] op_sel_hi:[1,0,1]
    v_pk_mul_f32 v[68:69], v[68:69], v[180:181]
    v_pk_mul_f32 v[70:71], v[70:71], v[182:183]
    v_exp_f32 v68, v68
    v_exp_f32 v69, v69
    v_exp_f32 v70, v70
    v_exp_f32 v71, v71
    v_pk_fma_f32 v[68:69], v[68:69], v[34:35], v[34:35] op_sel:[0,1,1] op_sel_hi:[1,1,1]
    v_pk_fma_f32 v[70:71], v[70:71], v[34:35], v[34:35] op_sel:[0,1,1] op_sel_hi:[1,1,1]
    v_rcp_f32 v68, v68
    v_rcp_f32 v69, v69
    v_rcp_f32 v70, v70
    v_rcp_f32 v71, v71
    s_nop 0
    v_pk_mul_f32 v[192:193], v[192:193], v[68:69]
    v_pk_mul_f32 v[194:195], v[194:195], v[70:71]
    v_cvt_pk_bf16_f32 v170, v192, v193
    v_cvt_pk_bf16_f32 v171, v194, v195
    s_mov_b32 s66, 98304
    s_nop 0
    v_permlane16_swap_b32 v168, v170
    v_permlane16_swap_b32 v169, v171
    buffer_store_dwordx4 v[168:171], v198, s[52:55], s66 offen offset:1024 sc1
    s_mov_b32 s15, 0
    s_mov_b64 exec, 1
    v_mov_b32 v1, 162820
    v_mov_b32 v2, 1
    s_lshr_b32 s71, s68, 7
    s_lshl_b32 s71, s71, 8
    s_add_u32 s71, s71, 4096
    s_waitcnt vmcnt(0)
    ds_add_rtn_u32 v3, v1, v2
    v_mov_b32 v1, 0
    s_waitcnt lgkmcnt(0)
    v_readfirstlane_b32 s72, v3
    s_nop 3
    s_cmp_lg_u32 s72, 3
    s_cbranch_scc1 pub_27
    buffer_atomic_add v2, v1, s[8:11], s71 offen offset:128
    s_add_u32 s72, s71, 1
    s_cmp_eq_u32 s67, 0
    s_cselect_b32 s15, s72, 0
    s_cbranch_scc1 pub_27
    buffer_atomic_add v2, v1, s[8:11], s71 offen sc1
pub_27:
    s_mov_b64 exec, -1
    s_and_b32 s71, s2, 7
    s_lshr_b32 s70, s2, 3
    s_mov_b32 s12, s70
    s_mov_b32 s13, s71
    s_and_b32 s73, s71, 1
    s_mul_i32 s73, s73, 6
    s_and_b32 s72, s70, 1
    s_add_u32 s73, s73, s72
    s_lshr_b32 s72, s71, 1
    s_lshl_b32 s72, s72, 3
    s_and_b32 s68, s70, 7
    s_add_u32 s68, s68, s72
    s_lshl_b32 s68, s68, 6
    s_and_b32 s71, s71, 1
    s_lshl_b32 s71, s71, 2
    s_lshr_b32 s70, s70, 3
    s_add_u32 s70, s70, s71
    s_mul_i32 s69, s70, 160
    s_add_u32 s40, s38, 8392704
    s_addc_u32 s41, s39, 0
    s_mov_b32 s42, 6291456
    s_mov_b32 s43, 0x00020000
    s_add_u32 s44, s38, 14716928
    s_addc_u32 s45, s39, 0
    s_mov_b32 s46, 6717440
    s_mov_b32 s47, 0x00020000
    s_mul_i32 s14, s70, 245760
    s_mov_b32 s48, s34
    s_mov_b32 s49, s35
    s_mov_b32 s50, 2621440
    s_mov_b32 s51, 0x00020000
    s_add_u32 s52, s38, 5640192
    s_addc_u32 s53, s39, 0
    s_mov_b32 s54, 2621440
    s_mov_b32 s55, 0x00020000
    v_and_b32 v7, 63, v0
    v_lshrrev_b32 v10, 6, v0
    v_and_b32 v8, 15, v0
    v_bfe_u32 v9, v0, 4, 2
    v_and_b32 v11, 1, v10
    v_lshrrev_b32 v12, 1, v10
    v_lshrrev_b32 v1, 1, v9
    v_lshlrev_b32 v1, 4, v1
    v_and_b32 v2, 1, v9
    v_lshl_add_u32 v1, v2, 2, v1
    v_lshrrev_b32 v2, 2, v8
    v_add_u32 v1, v1, v2
    v_mov_b32 v2, 64
    v_mad_u32_u24 v1, v12, v2, v1
    v_mul_u32_u24 v1, 160, v1
    v_and_b32 v2, 3, v8
    v_lshl_add_u32 v1, v2, 3, v1
    v_mov_b32 v13, v1
    v_mul_u32_u24 v1, 8192, v11
    v_lshl_add_u32 v1, v7, 4, v1
    v_mul_u32_u24 v3, 2048, v12
    v_add_u32 v14, v1, v3
    v_mul_u32_u24 v1, 32, v11
    v_add_u32 v1, v1, v8
    v_and_b32 v2, 15, v1
    v_mul_u32_u24 v1, 256, v1
    v_mul_u32_u24 v3, 4096, v12
    v_sub_u32 v4, 4096, v3
    v_add_u32 v15, v4, v14
    v_add_u32 v14, v3, v14
    v_add_u32 v13, 8192, v13
    v_add_u32 v14, 8192, v14
    v_add_u32 v15, 8192, v15
    v_mov_b32 v72, 0
    v_mov_b32 v73, 0
    v_mov_b32 v74, 0
    v_mov_b32 v75, 0
    v_mov_b32 v76, 0
    v_mov_b32 v77, 0
    v_mov_b32 v78, 0
    v_mov_b32 v79, 0
    v_mov_b32 v80, 0
    v_mov_b32 v81, 0
    v_mov_b32 v82, 0
    v_mov_b32 v83, 0
    v_mov_b32 v84, 0
    v_mov_b32 v85, 0
    v_mov_b32 v86, 0
    v_mov_b32 v87, 0
    v_mov_b32 v88, 0
    v_mov_b32 v89, 0
    v_mov_b32 v90, 0
    v_mov_b32 v91, 0
    v_mov_b32 v92, 0
    v_mov_b32 v93, 0
    v_mov_b32 v94, 0
    v_mov_b32 v95, 0
    v_mov_b32 v96, 0
    v_mov_b32 v97, 0
    v_mov_b32 v98, 0
    v_mov_b32 v99, 0
    v_mov_b32 v100, 0
    v_mov_b32 v101, 0
    v_mov_b32 v102, 0
    v_mov_b32 v103, 0
    v_mov_b32 v104, 0
    v_mov_b32 v105, 0
    v_mov_b32 v106, 0
    v_mov_b32 v107, 0
    v_mov_b32 v108, 0
    v_mov_b32 v109, 0
    v_mov_b32 v110, 0
    v_mov_b32 v111, 0
    v_lshl_add_u32 v113, v11, 1, v12
    v_lshl_add_u32 v113, v113, 4, v8
    v_add_u32 v113, s68, v113
    v_mul_u32_u24 v1, 1280, v113
    v_add_u32 v1, s69, v1
    v_lshl_add_u32 v112, v9, 3, v1
    v_and_b32 v2, 1, v9
    v_lshl_add_u32 v114, v2, 5, v1
    v_lshrrev_b32 v2, 1, v9
    v_lshl_add_u32 v114, v2, 4, v114
    v_and_b32 v1, 0xfff0, v113
    v_mul_u32_u24 v1, 1280, v1
    v_lshl_add_u32 v1, v8, 4, v1
    s_lshl_b32 s71, s69, 4
    v_add_u32 v1, s71, v1
    v_lshl_add_u32 v1, v2, 8, v1
    v_and_b32 v2, 1, v9
    v_lshl_add_u32 v115, v2, 3, v1
    v_lshl_add_u32 v116, v2, 9, v1
    s_cmp_lg_u32 s67, 0
    s_cbranch_scc1 aw_29
    s_mov_b64 exec, 1
    v_mov_b32 v1, 0
    s_lshr_b32 s71, s68, 7
    s_lshl_b32 s71, s71, 8
    s_add_u32 s71, s71, 4096
    s_mov_b32 s65, 0x20000
aw_28:
    s_and_b32 s72, s65, 7
    s_cmp_eq_u32 s72, 1
    s_cbranch_scc1 aw_30
    v_mov_b32 v2, 0
    buffer_atomic_add v2, v1, s[8:11], s71 offen offset:128 sc0
    s_branch aw_31
aw_30:
    s_cmp_eq_u32 s15, 0
    s_cbranch_scc1 df_32
    s_sub_u32 s15, s15, 1
    v_mov_b32 v243, 1
    buffer_atomic_add v243, v1, s[8:11], s15 offen sc1
    s_mov_b32 s15, 0
df_32:
    buffer_load_dword v2, v1, s[8:11], s71 offen sc1
aw_31:
    s_sub_u32 s65, s65, 1
    s_waitcnt vmcnt(0)
    v_readfirstlane_b32 s72, v2
    s_cmp_eq_u32 s65, 0
    s_cselect_b32 s66, 16, 0
    s_max_u32 s72, s72, s66
    s_cmp_lt_u32 s72, 16
    s_cbranch_scc1 aw_28
    s_cmp_eq_u32 s15, 0
    s_cbranch_scc1 df_33
    s_sub_u32 s15, s15, 1
    v_mov_b32 v243, 1
    buffer_atomic_add v243, v1, s[8:11], s15 offen sc1
    s_mov_b32 s15, 0
df_33:
    s_mov_b64 exec, -1
aw_29:
    s_barrier
    buffer_load_dwordx2 v[118:119], v115, s[52:55], 0 offen offset:0 sc1
    buffer_load_dwordx2 v[120:121], v115, s[52:55], 0 offen offset:512 sc1
    buffer_load_dwordx2 v[122:123], v115, s[52:55], 0 offen offset:1024 sc1
    buffer_load_dwordx2 v[124:125], v115, s[52:55], 0 offen offset:1536 sc1
    buffer_load_dwordx2 v[126:127], v115, s[52:55], 0 offen offset:2048 sc1
    s_mov_b32 s76, 12
    s_mov_b32 s77, 0
    s_barrier
    ds_read_b128 v[56:59], v14 offset:0
    ds_read_b128 v[60:63], v15 offset:0
    ds_read_b64_tr_b16 v[16:17], v13 offset:16384
    ds_read_b64_tr_b16 v[18:19], v13 offset:17664
    ds_read_b64_tr_b16 v[20:21], v13 offset:16416
    ds_read_b64_tr_b16 v[22:23], v13 offset:17696
    ds_read_b64_tr_b16 v[24:25], v13 offset:16448
    ds_read_b64_tr_b16 v[26:27], v13 offset:17728
    ds_read_b64_tr_b16 v[28:29], v13 offset:16480
    ds_read_b64_tr_b16 v[30:31], v13 offset:17760
    ds_read_b64_tr_b16 v[32:33], v13 offset:16512
    ds_read_b64_tr_b16 v[34:35], v13 offset:17792
k5_loop:
    s_waitcnt lgkmcnt(0)
    v_mfma_f32_16x16x32_bf16 v[72:75], v[16:19], v[56:59], v[72:75]
    ds_read_b128 v[64:67], v14 offset:1024
    ds_read_b128 v[68:71], v15 offset:1024
    v_mfma_f32_16x16x32_bf16 v[92:95], v[16:19], v[60:63], v[92:95]
    ds_read_b64_tr_b16 v[36:37], v13 offset:21504
    ds_read_b64_tr_b16 v[38:39], v13 offset:22784
    v_mfma_f32_16x16x32_bf16 v[76:79], v[20:23], v[56:59], v[76:79]
    ds_read_b64_tr_b16 v[40:41], v13 offset:21536
    ds_read_b64_tr_b16 v[42:43], v13 offset:22816
    v_mfma_f32_16x16x32_bf16 v[96:99], v[20:23], v[60:63], v[96:99]
    ds_read_b64_tr_b16 v[44:45], v13 offset:21568
    ds_read_b64_tr_b16 v[46:47], v13 offset:22848
    v_mfma_f32_16x16x32_bf16 v[80:83], v[24:27], v[56:59], v[80:83]
    ds_read_b64_tr_b16 v[48:49], v13 offset:21600
    ds_read_b64_tr_b16 v[50:51], v13 offset:22880
    v_mfma_f32_16x16x32_bf16 v[100:103], v[24:27], v[60:63], v[100:103]
    ds_read_b64_tr_b16 v[52:53], v13 offset:21632
    ds_read_b64_tr_b16 v[54:55], v13 offset:22912
    v_mfma_f32_16x16x32_bf16 v[84:87], v[28:31], v[56:59], v[84:87]
    s_mov_b32 s79, s77
    s_add_u32 s77, s77, 36864
    s_cmp_ge_u32 s77, 147456
    s_cselect_b32 s77, 0, s77
    s_sub_u32 s79, s77, s79
    v_mfma_f32_16x16x32_bf16 v[104:107], v[28:31], v[60:63], v[104:107]
    v_add_u32 v13, s79, v13
    v_add_u32 v14, s79, v14
    v_mfma_f32_16x16x32_bf16 v[88:91], v[32:35], v[56:59], v[88:91]
    v_add_u32 v15, s79, v15
    v_mfma_f32_16x16x32_bf16 v[108:111], v[32:35], v[60:63], v[108:111]
    s_waitcnt lgkmcnt(0)
    v_mfma_f32_16x16x32_bf16 v[72:75], v[36:39], v[64:67], v[72:75]
    s_barrier
    v_mfma_f32_16x16x32_bf16 v[92:95], v[36:39], v[68:71], v[92:95]
    ds_read_b128 v[56:59], v14 offset:0
    ds_read_b128 v[60:63], v15 offset:0
    v_mfma_f32_16x16x32_bf16 v[76:79], v[40:43], v[64:67], v[76:79]
    ds_read_b64_tr_b16 v[16:17], v13 offset:16384
    ds_read_b64_tr_b16 v[18:19], v13 offset:17664
    v_mfma_f32_16x16x32_bf16 v[96:99], v[40:43], v[68:71], v[96:99]
    ds_read_b64_tr_b16 v[20:21], v13 offset:16416
    ds_read_b64_tr_b16 v[22:23], v13 offset:17696
    v_mfma_f32_16x16x32_bf16 v[80:83], v[44:47], v[64:67], v[80:83]
    ds_read_b64_tr_b16 v[24:25], v13 offset:16448
    ds_read_b64_tr_b16 v[26:27], v13 offset:17728
    v_mfma_f32_16x16x32_bf16 v[100:103], v[44:47], v[68:71], v[100:103]
    ds_read_b64_tr_b16 v[28:29], v13 offset:16480
    ds_read_b64_tr_b16 v[30:31], v13 offset:17760
    v_mfma_f32_16x16x32_bf16 v[84:87], v[48:51], v[64:67], v[84:87]
    ds_read_b64_tr_b16 v[32:33], v13 offset:16512
    ds_read_b64_tr_b16 v[34:35], v13 offset:17792
    v_mfma_f32_16x16x32_bf16 v[104:107], v[48:51], v[68:71], v[104:107]
    s_sub_u32 s76, s76, 1
    s_cmp_lg_u32 s76, 0
    v_mfma_f32_16x16x32_bf16 v[88:91], v[52:55], v[64:67], v[88:91]
    v_mfma_f32_16x16x32_bf16 v[108:111], v[52:55], v[68:71], v[108:111]
    s_cbranch_scc1 k5_loop
    s_waitcnt vmcnt(0) lgkmcnt(0)
    s_nop 7
    v_mul_u32_u24 v1, 5120, v10
    v_lshl_add_u32 v1, v7, 4, v1
    v_add_u32 v1, 0, v1
    v_xor_b32 v2, 2, v10
    v_mul_u32_u24 v2, 5120, v2
    v_lshl_add_u32 v2, v7, 4, v2
    v_add_u32 v2, 0, v2
    ds_write_b128 v1, v[92:95] offset:0
    ds_write_b128 v1, v[96:99] offset:1024
    ds_write_b128 v1, v[100:103] offset:2048
    ds_write_b128 v1, v[104:107] offset:3072
    ds_write_b128 v1, v[108:111] offset:4096
    s_waitcnt lgkmcnt(0)
    s_barrier
    ds_read_b128 v[92:95], v2 offset:0
    ds_read_b128 v[96:99], v2 offset:1024
    ds_read_b128 v[100:103], v2 offset:2048
    ds_read_b128 v[104:107], v2 offset:3072
    ds_read_b128 v[108:111], v2 offset:4096
    s_waitcnt lgkmcnt(4)
    v_lshlrev_b32 v2, 16, v118
    v_and_b32 v3, 0xffff0000, v118
    v_pk_add_f32 v[72:73], v[72:73], v[92:93]
    v_cvt_pk_bf16_f32 v73, v72, v73
    v_lshlrev_b32 v72, 16, v73
    v_and_b32 v73, 0xffff0000, v73
    v_pk_add_f32 v[2:3], v[2:3], v[72:73]
    v_cvt_pk_bf16_f32 v92, v2, v3
    v_lshlrev_b32 v4, 16, v119
    v_and_b32 v5, 0xffff0000, v119
    v_pk_add_f32 v[74:75], v[74:75], v[94:95]
    v_cvt_pk_bf16_f32 v75, v74, v75
    v_lshlrev_b32 v74, 16, v75
    v_and_b32 v75, 0xffff0000, v75
    v_pk_add_f32 v[4:5], v[4:5], v[74:75]
    v_cvt_pk_bf16_f32 v93, v4, v5
    s_waitcnt lgkmcnt(3)
    v_lshlrev_b32 v2, 16, v120
    v_and_b32 v3, 0xffff0000, v120
    v_pk_add_f32 v[76:77], v[76:77], v[96:97]
    v_cvt_pk_bf16_f32 v77, v76, v77
    v_lshlrev_b32 v76, 16, v77
    v_and_b32 v77, 0xffff0000, v77
    v_pk_add_f32 v[2:3], v[2:3], v[76:77]
    v_cvt_pk_bf16_f32 v94, v2, v3
    v_lshlrev_b32 v4, 16, v121
    v_and_b32 v5, 0xffff0000, v121
    v_pk_add_f32 v[78:79], v[78:79], v[98:99]
    v_cvt_pk_bf16_f32 v79, v78, v79
    v_lshlrev_b32 v78, 16, v79
    v_and_b32 v79, 0xffff0000, v79
    v_pk_add_f32 v[4:5], v[4:5], v[78:79]
    v_cvt_pk_bf16_f32 v95, v4, v5
    s_nop 1
    v_permlane16_swap_b32 v92, v94
    v_permlane16_swap_b32 v93, v95
    buffer_store_dwordx4 v[92:95], v114, s[48:51], 0 offen offset:0
    s_waitcnt lgkmcnt(2)
    v_lshlrev_b32 v2, 16, v122
    v_and_b32 v3, 0xffff0000, v122
    v_pk_add_f32 v[80:81], v[80:81], v[100:101]
    v_cvt_pk_bf16_f32 v81, v80, v81
    v_lshlrev_b32 v80, 16, v81
    v_and_b32 v81, 0xffff0000, v81
    v_pk_add_f32 v[2:3], v[2:3], v[80:81]
    v_cvt_pk_bf16_f32 v100, v2, v3
    v_lshlrev_b32 v4, 16, v123
    v_and_b32 v5, 0xffff0000, v123
    v_pk_add_f32 v[82:83], v[82:83], v[102:103]
    v_cvt_pk_bf16_f32 v83, v82, v83
    v_lshlrev_b32 v82, 16, v83
    v_and_b32 v83, 0xffff0000, v83
    v_pk_add_f32 v[4:5], v[4:5], v[82:83]
    v_cvt_pk_bf16_f32 v101, v4, v5
    s_waitcnt lgkmcnt(1)
    v_lshlrev_b32 v2, 16, v124
    v_and_b32 v3, 0xffff0000, v124
    v_pk_add_f32 v[84:85], v[84:85], v[104:105]
    v_cvt_pk_bf16_f32 v85, v84, v85
    v_lshlrev_b32 v84, 16, v85
    v_and_b32 v85, 0xffff0000, v85
    v_pk_add_f32 v[2:3], v[2:3], v[84:85]
    v_cvt_pk_bf16_f32 v102, v2, v3
    v_lshlrev_b32 v4, 16, v125
    v_and_b32 v5, 0xffff0000, v125
    v_pk_add_f32 v[86:87], v[86:87], v[106:107]
    v_cvt_pk_bf16_f32 v87, v86, v87
    v_lshlrev_b32 v86, 16, v87
    v_and_b32 v87, 0xffff0000, v87
    v_pk_add_f32 v[4:5], v[4:5], v[86:87]
    v_cvt_pk_bf16_f32 v103, v4, v5
    s_nop 1
    v_permlane16_swap_b32 v100, v102
    v_permlane16_swap_b32 v101, v103
    buffer_store_dwordx4 v[100:103], v114, s[48:51], 0 offen offset:64
    s_waitcnt lgkmcnt(0)
    v_lshlrev_b32 v2, 16, v126
    v_and_b32 v3, 0xffff0000, v126
    v_pk_add_f32 v[88:89], v[88:89], v[108:109]
    v_cvt_pk_bf16_f32 v89, v88, v89
    v_lshlrev_b32 v88, 16, v89
    v_and_b32 v89, 0xffff0000, v89
    v_pk_add_f32 v[2:3], v[2:3], v[88:89]
    v_cvt_pk_bf16_f32 v108, v2, v3
    v_lshlrev_b32 v4, 16, v127
    v_and_b32 v5, 0xffff0000, v127
    v_pk_add_f32 v[90:91], v[90:91], v[110:111]
    v_cvt_pk_bf16_f32 v91, v90, v91
    v_lshlrev_b32 v90, 16, v91
    v_and_b32 v91, 0xffff0000, v91
    v_pk_add_f32 v[4:5], v[4:5], v[90:91]
    v_cvt_pk_bf16_f32 v109, v4, v5
    buffer_store_dwordx2 v[108:109], v112, s[48:51], 0 offen offset:128
k2_end:
    s_endpgm
k2_sy:
    s_cmp_eq_u32 s77, 6
    s_cbranch_scc1 k2_sy2
    s_barrier
    s_branch k2_nb1
k2_sy2:
kw_34:
    ds_read_b128 v[2:5], v10 offset:16
    s_waitcnt lgkmcnt(0)
    v_and_b32 v2, v2, v3
    v_and_b32 v4, v4, v5
    v_and_b32 v2, v2, v4
    s_nop 0
    v_readfirstlane_b32 s72, v2
    s_nop 3
    s_cmp_lg_u32 s72, -1
    s_cbranch_scc1 kw_34
    buffer_load_dwordx2 v[244:245], v254, s[48:51], 0 offen offset:0
    buffer_load_dwordx2 v[246:247], v254, s[48:51], 0 offen offset:32
    buffer_load_dwordx2 v[248:249], v254, s[48:51], 0 offen offset:64
    buffer_load_dwordx2 v[250:251], v254, s[48:51], 0 offen offset:96
    buffer_load_dwordx2 v[252:253], v254, s[48:51], 0 offen offset:128
    s_branch k2_nb1
k2_slow:
    v_mov_b32 v82, 0
    v_mov_b32 v22, 0xff800000
    v_mov_b32 v90, 0
    v_mov_b32 v23, 0xff800000
    v_subrev_u32 v19, 143360, v16
    v_subrev_u32 v20, 143360, v17
    v_subrev_u32 v21, 143360, v18
    s_mov_b32 s78, 0
k2_slow1:
    buffer_load_dwordx4 v[172:175], v19, s[44:47], s78 offen
    buffer_load_dwordx2 v[176:177], v20, s[44:47], s78 offen
    s_waitcnt vmcnt(0)
    v_mfma_f32_32x32x16_bf16 v[92:107], v[172:175], v[76:79], 0
    v_mfma_f32_32x32x16_bf16 v[92:107], v[176:179], v[80:83], v[92:107]
    v_mfma_f32_32x32x16_bf16 v[124:139], v[172:175], v[84:87], 0
    v_mfma_f32_32x32x16_bf16 v[124:139], v[176:179], v[88:91], v[124:139]
    s_nop 7
    s_nop 7
    v_max3_f32 v22, v92, v93, v22
    v_max3_f32 v22, v94, v95, v22
    v_max3_f32 v22, v96, v97, v22
    v_max3_f32 v22, v98, v99, v22
    v_max3_f32 v22, v100, v101, v22
    v_max3_f32 v22, v102, v103, v22
    v_max3_f32 v22, v104, v105, v22
    v_max3_f32 v22, v106, v107, v22
    v_max3_f32 v23, v124, v125, v23
    v_max3_f32 v23, v126, v127, v23
    v_max3_f32 v23, v128, v129, v23
    v_max3_f32 v23, v130, v131, v23
    v_max3_f32 v23, v132, v133, v23
    v_max3_f32 v23, v134, v135, v23
    v_max3_f32 v23, v136, v137, v23
    v_max3_f32 v23, v138, v139, v23
    s_add_u32 s78, s78, 2560
    s_cmp_lt_u32 s78, 163840
    s_cbranch_scc1 k2_slow1
    v_cmp_eq_u32 vcc, 0, v13
    v_xor_b32 v1, 32, v11
    v_lshlrev_b32 v1, 2, v1
    ds_bpermute_b32 v2, v1, v22
    s_waitcnt lgkmcnt(0)
    v_max_f32 v22, v22, v2
    v_cvt_pk_bf16_f32 v3, -v22, 0
    v_cndmask_b32 v82, 0, v3, vcc
    v_mov_b32 v28, 0
    v_mov_b32 v29, 0
    v_mov_b32 v30, 0
    v_mov_b32 v31, 0
    v_mov_b32 v32, 0
    v_mov_b32 v33, 0
    v_mov_b32 v34, 0
    v_mov_b32 v35, 0
    v_mov_b32 v36, 0
    v_mov_b32 v37, 0
    v_mov_b32 v38, 0
    v_mov_b32 v39, 0
    v_mov_b32 v40, 0
    v_mov_b32 v41, 0
    v_mov_b32 v42, 0
    v_mov_b32 v43, 0
    v_xor_b32 v1, 32, v11
    v_lshlrev_b32 v1, 2, v1
    ds_bpermute_b32 v2, v1, v23
    s_waitcnt lgkmcnt(0)
    v_max_f32 v23, v23, v2
    v_cvt_pk_bf16_f32 v3, -v23, 0
    v_cndmask_b32 v90, 0, v3, vcc
    v_mov_b32 v44, 0
    v_mov_b32 v45, 0
    v_mov_b32 v46, 0
    v_mov_b32 v47, 0
    v_mov_b32 v48, 0
    v_mov_b32 v49, 0
    v_mov_b32 v50, 0
    v_mov_b32 v51, 0
    v_mov_b32 v52, 0
    v_mov_b32 v53, 0
    v_mov_b32 v54, 0
    v_mov_b32 v55, 0
    v_mov_b32 v56, 0
    v_mov_b32 v57, 0
    v_mov_b32 v58, 0
    v_mov_b32 v59, 0
    v_subrev_u32 v19, 143360, v16
    v_subrev_u32 v20, 143360, v17
    v_subrev_u32 v21, 143360, v18
    s_mov_b32 s78, 0
k2_slow2:
    buffer_load_dwordx4 v[172:175], v19, s[44:47], s78 offen
    buffer_load_dwordx2 v[176:177], v20, s[44:47], s78 offen
    s_mov_b64 exec, s[4:5]
    buffer_load_dwordx4 v[60:63], v21, s[44:47], s78 offen
    buffer_load_dwordx4 v[64:67], v21, s[44:47], s78 offen offset:640
    s_mov_b64 exec, -1
    s_waitcnt vmcnt(0)
    v_mfma_f32_32x32x16_bf16 v[92:107], v[172:175], v[76:79], 0
    v_mfma_f32_32x32x16_bf16 v[92:107], v[176:179], v[80:83], v[92:107]
    v_mfma_f32_32x32x16_bf16 v[124:139], v[172:175], v[84:87], 0
    v_mfma_f32_32x32x16_bf16 v[124:139], v[176:179], v[88:91], v[124:139]
    s_nop 7
    s_nop 7
    v_exp_f32 v92, v92
    v_exp_f32 v93, v93
    v_exp_f32 v94, v94
    v_exp_f32 v95, v95
    v_exp_f32 v96, v96
    v_exp_f32 v97, v97
    v_exp_f32 v98, v98
    v_exp_f32 v99, v99
    v_exp_f32 v100, v100
    v_exp_f32 v101, v101
    v_exp_f32 v102, v102
    v_exp_f32 v103, v103
    v_exp_f32 v104, v104
    v_exp_f32 v105, v105
    v_exp_f32 v106, v106
    v_exp_f32 v107, v107
    s_nop 0
    v_cvt_pk_bf16_f32 v156, v92, v93
    v_cvt_pk_bf16_f32 v157, v94, v95
    v_cvt_pk_bf16_f32 v158, v96, v97
    v_cvt_pk_bf16_f32 v159, v98, v99
    v_cvt_pk_bf16_f32 v160, v100, v101
    v_cvt_pk_bf16_f32 v161, v102, v103
    v_cvt_pk_bf16_f32 v162, v104, v105
    v_cvt_pk_bf16_f32 v163, v106, v107
    v_exp_f32 v124, v124
    v_exp_f32 v125, v125
    v_exp_f32 v126, v126
    v_exp_f32 v127, v127
    v_exp_f32 v128, v128
    v_exp_f32 v129, v129
    v_exp_f32 v130, v130
    v_exp_f32 v131, v131
    v_exp_f32 v132, v132
    v_exp_f32 v133, v133
    v_exp_f32 v134, v134
    v_exp_f32 v135, v135
    v_exp_f32 v136, v136
    v_exp_f32 v137, v137
    v_exp_f32 v138, v138
    v_exp_f32 v139, v139
    s_nop 0
    v_cvt_pk_bf16_f32 v164, v124, v125
    v_cvt_pk_bf16_f32 v165, v126, v127
    v_cvt_pk_bf16_f32 v166, v128, v129
    v_cvt_pk_bf16_f32 v167, v130, v131
    v_cvt_pk_bf16_f32 v168, v132, v133
    v_cvt_pk_bf16_f32 v169, v134, v135
    v_cvt_pk_bf16_f32 v170, v136, v137
    v_cvt_pk_bf16_f32 v171, v138, v139
    s_nop 1
    v_mfma_f32_32x32x16_bf16 v[28:43], v[60:63], v[156:159], v[28:43]
    v_mfma_f32_32x32x16_bf16 v[28:43], v[64:67], v[160:163], v[28:43]
    v_mfma_f32_32x32x16_bf16 v[44:59], v[60:63], v[164:167], v[44:59]
    v_mfma_f32_32x32x16_bf16 v[44:59], v[64:67], v[168:171], v[44:59]
    s_nop 7
    s_nop 7
    s_add_u32 s78, s78, 2560
    s_cmp_lt_u32 s78, 163840
    s_cbranch_scc1 k2_slow2
    s_branch k2_epi
k2_helper:
    s_mov_b32 s44, s18
    s_mov_b32 s45, s19
    s_mov_b32 s46, 819200
    s_mov_b32 s47, 0x00020000
    s_add_u32 s48, s38, 2621440
    s_addc_u32 s49, s39, 0
    s_mov_b32 s50, 163840
    s_mov_b32 s51, 0x00020000
    s_and_b32 s64, s67, 3
    s_lshl_b32 s64, s64, 10
    v_lshrrev_b32 v41, 4, v0
    v_and_b32 v42, 15, v0
    v_and_b32 v43, 15, v41
    v_xor_b32 v42, v42, v43
    v_add_u32 v41, s68, v41
    v_mul_u32_u24 v41, 1280, v41
    v_lshl_add_u32 v46, v42, 4, v41
    v_add_u32 v40, 0, v0
    v_mul_u32_u24 v41, 52429, v40
    v_lshrrev_b32 v41, 19, v41
    v_mul_u32_u24 v42, 10, v41
    v_sub_u32 v42, v40, v42
    v_and_b32 v43, 0xfffffff3, v41
    v_bfe_u32 v44, v41, 2, 1
    v_lshl_or_b32 v43, v44, 3, v43
    v_bfe_u32 v44, v41, 3, 1
    v_lshl_or_b32 v43, v44, 2, v43
    v_mul_u32_u24 v43, 1280, v43
    v_lshl_add_u32 v47, v42, 4, v43
    v_add_u32 v47, s69, v47
    v_add_u32 v40, 256, v0
    v_mul_u32_u24 v41, 52429, v40
    v_lshrrev_b32 v41, 19, v41
    v_mul_u32_u24 v42, 10, v41
    v_sub_u32 v42, v40, v42
    v_and_b32 v43, 0xfffffff3, v41
    v_bfe_u32 v44, v41, 2, 1
    v_lshl_or_b32 v43, v44, 3, v43
    v_bfe_u32 v44, v41, 3, 1
    v_lshl_or_b32 v43, v44, 2, v43
    v_mul_u32_u24 v43, 1280, v43
    v_lshl_add_u32 v48, v42, 4, v43
    v_add_u32 v48, s69, v48
    v_add_u32 v40, 512, v0
    v_mul_u32_u24 v41, 52429, v40
    v_lshrrev_b32 v41, 19, v41
    v_mul_u32_u24 v42, 10, v41
    v_sub_u32 v42, v40, v42
    v_and_b32 v43, 0xfffffff3, v41
    v_bfe_u32 v44, v41, 2, 1
    v_lshl_or_b32 v43, v44, 3, v43
    v_bfe_u32 v44, v41, 3, 1
    v_lshl_or_b32 v43, v44, 2, v43
    v_mul_u32_u24 v43, 1280, v43
    v_lshl_add_u32 v49, v42, 4, v43
    v_add_u32 v49, s69, v49
    v_add_u32 v40, 768, v0
    v_mul_u32_u24 v41, 52429, v40
    v_lshrrev_b32 v41, 19, v41
    v_mul_u32_u24 v42, 10, v41
    v_sub_u32 v42, v40, v42
    v_and_b32 v43, 0xfffffff3, v41
    v_bfe_u32 v44, v41, 2, 1
    v_lshl_or_b32 v43, v44, 3, v43
    v_bfe_u32 v44, v41, 3, 1
    v_lshl_or_b32 v43, v44, 2, v43
    v_mul_u32_u24 v43, 1280, v43
    v_lshl_add_u32 v50, v42, 4, v43
    v_add_u32 v50, s69, v50
    v_add_u32 v40, 1024, v0
    v_mul_u32_u24 v41, 52429, v40
    v_lshrrev_b32 v41, 19, v41
    v_mul_u32_u24 v42, 10, v41
    v_sub_u32 v42, v40, v42
    v_and_b32 v43, 0xfffffff3, v41
    v_bfe_u32 v44, v41, 2, 1
    v_lshl_or_b32 v43, v44, 3, v43
    v_bfe_u32 v44, v41, 3, 1
    v_lshl_or_b32 v43, v44, 2, v43
    v_mul_u32_u24 v43, 1280, v43
    v_lshl_add_u32 v51, v42, 4, v43
    v_add_u32 v51, s69, v51
    s_mov_b32 s78, 0
    s_mul_i32 s65, s78, 256
    s_add_u32 m0, s64, 53248
    s_nop 0
    buffer_load_dwordx4 v46, s[40:43], s65 offen  lds
    s_add_u32 m0, s64, 57344
    s_add_u32 s65, s65, 20480
    buffer_load_dwordx4 v46, s[40:43], s65 offen  lds
    s_add_u32 m0, s64, 61440
    s_add_u32 s65, s65, 20480
    buffer_load_dwordx4 v46, s[40:43], s65 offen  lds
    s_add_u32 m0, s64, 65536
    s_add_u32 s65, s65, 20480
    buffer_load_dwordx4 v46, s[40:43], s65 offen  lds
    s_mul_i32 s66, s78, 163840
    s_add_u32 m0, s64, 69632
    s_nop 0
    buffer_load_dwordx4 v47, s[44:47], s66 offen lds
    s_add_u32 m0, s64, 73728
    s_nop 0
    buffer_load_dwordx4 v48, s[44:47], s66 offen lds
    s_add_u32 m0, s64, 77824
    s_nop 0
    buffer_load_dwordx4 v49, s[44:47], s66 offen lds
    s_add_u32 m0, s64, 81920
    s_nop 0
    buffer_load_dwordx4 v50, s[44:47], s66 offen lds
    s_add_u32 m0, s64, 86016
    s_nop 0
    buffer_load_dwordx4 v51, s[44:47], s66 offen lds
    s_lshl_b32 s7, s13, 8
    s_add_u32 s7, s7, 22528
    v_lshlrev_b32 v34, 3, v11
    s_add_u32 s56, s38, 2883584
    s_addc_u32 s57, s39, 0
    s_mov_b32 s58, 512
    s_mov_b32 s59, 0x00020000
    v_add_u32 v1, 0, v11
    v_mul_u32_u24 v2, 43691, v1
    v_lshrrev_b32 v2, 19, v2
    v_mul_u32_u24 v3, 12, v2
    v_sub_u32 v3, v1, v3
    v_and_b32 v4, 0xfffffff3, v2
    v_bfe_u32 v5, v2, 2, 1
    v_lshlrev_b32 v6, 1, v5
    v_xor_b32 v3, v3, v6
    v_lshl_or_b32 v4, v5, 3, v4
    v_bfe_u32 v5, v2, 3, 1
    v_lshl_or_b32 v4, v5, 2, v4
    v_mul_u32_u24 v4, 3072, v4
    v_lshl_add_u32 v141, v3, 4, v4
    v_add_u32 v1, 64, v11
    v_mul_u32_u24 v2, 43691, v1
    v_lshrrev_b32 v2, 19, v2
    v_mul_u32_u24 v3, 12, v2
    v_sub_u32 v3, v1, v3
    v_and_b32 v4, 0xfffffff3, v2
    v_bfe_u32 v5, v2, 2, 1
    v_lshlrev_b32 v6, 1, v5
    v_xor_b32 v3, v3, v6
    v_lshl_or_b32 v4, v5, 3, v4
    v_bfe_u32 v5, v2, 3, 1
    v_lshl_or_b32 v4, v5, 2, v4
    v_mul_u32_u24 v4, 3072, v4
    v_lshl_add_u32 v142, v3, 4, v4
    v_add_u32 v1, 128, v11
    v_mul_u32_u24 v2, 43691, v1
    v_lshrrev_b32 v2, 19, v2
    v_mul_u32_u24 v3, 12, v2
    v_sub_u32 v3, v1, v3
    v_and_b32 v4, 0xfffffff3, v2
    v_bfe_u32 v5, v2, 2, 1
    v_lshlrev_b32 v6, 1, v5
    v_xor_b32 v3, v3, v6
    v_lshl_or_b32 v4, v5, 3, v4
    v_bfe_u32 v5, v2, 3, 1
    v_lshl_or_b32 v4, v5, 2, v4
    v_mul_u32_u24 v4, 3072, v4
    v_lshl_add_u32 v143, v3, 4, v4
    v_add_u32 v1, 0, v11
    v_mul_u32_u24 v2, 52429, v1
    v_lshrrev_b32 v2, 19, v2
    v_mul_u32_u24 v3, 10, v2
    v_sub_u32 v3, v1, v3
    v_and_b32 v4, 0xfffffff3, v2
    v_bfe_u32 v5, v2, 2, 1
    v_lshl_or_b32 v4, v5, 3, v4
    v_bfe_u32 v5, v2, 3, 1
    v_lshl_or_b32 v4, v5, 2, v4
    v_mul_u32_u24 v4, 1280, v4
    v_lshl_add_u32 v136, v3, 4, v4
    v_add_u32 v1, 64, v11
    v_mul_u32_u24 v2, 52429, v1
    v_lshrrev_b32 v2, 19, v2
    v_mul_u32_u24 v3, 10, v2
    v_sub_u32 v3, v1, v3
    v_and_b32 v4, 0xfffffff3, v2
    v_bfe_u32 v5, v2, 2, 1
    v_lshl_or_b32 v4, v5, 3, v4
    v_bfe_u32 v5, v2, 3, 1
    v_lshl_or_b32 v4, v5, 2, v4
    v_mul_u32_u24 v4, 1280, v4
    v_lshl_add_u32 v137, v3, 4, v4
    v_add_u32 v1, 128, v11
    v_mul_u32_u24 v2, 52429, v1
    v_lshrrev_b32 v2, 19, v2
    v_mul_u32_u24 v3, 10, v2
    v_sub_u32 v3, v1, v3
    v_and_b32 v4, 0xfffffff3, v2
    v_bfe_u32 v5, v2, 2, 1
    v_lshl_or_b32 v4, v5, 3, v4
    v_bfe_u32 v5, v2, 3, 1
    v_lshl_or_b32 v4, v5, 2, v4
    v_mul_u32_u24 v4, 1280, v4
    v_lshl_add_u32 v138, v3, 4, v4
    v_add_u32 v1, 192, v11
    v_mul_u32_u24 v2, 52429, v1
    v_lshrrev_b32 v2, 19, v2
    v_mul_u32_u24 v3, 10, v2
    v_sub_u32 v3, v1, v3
    v_and_b32 v4, 0xfffffff3, v2
    v_bfe_u32 v5, v2, 2, 1
    v_lshl_or_b32 v4, v5, 3, v4
    v_bfe_u32 v5, v2, 3, 1
    v_lshl_or_b32 v4, v5, 2, v4
    v_mul_u32_u24 v4, 1280, v4
    v_lshl_add_u32 v139, v3, 4, v4
    v_add_u32 v1, 256, v11
    v_mul_u32_u24 v2, 52429, v1
    v_lshrrev_b32 v2, 19, v2
    v_mul_u32_u24 v3, 10, v2
    v_sub_u32 v3, v1, v3
    v_and_b32 v4, 0xfffffff3, v2
    v_bfe_u32 v5, v2, 2, 1
    v_lshl_or_b32 v4, v5, 3, v4
    v_bfe_u32 v5, v2, 3, 1
    v_lshl_or_b32 v4, v5, 2, v4
    v_mul_u32_u24 v4, 1280, v4
    v_lshl_add_u32 v140, v3, 4, v4
    v_lshlrev_b32 v144, 7, v11
    s_lshl_b32 s72, s67, 2
    v_mov_b32 v145, s72
    v_mov_b32 v146, -1
    v_lshrrev_b32 v1, 3, v11
    v_mul_u32_u24 v1, 3072, v1
    v_and_b32 v2, 7, v11
    v_lshl_add_u32 v147, v2, 4, v1
    v_and_b32 v1, 16, v11
    v_lshl_add_u32 v148, v2, 5, v1
    v_and_b32 v1, 1, v11
    v_lshlrev_b32 v1, 4, v1
    v_mov_b32 v2, 0x3f80
    v_lshlrev_b32 v1, v1, v2
    v_bfe_u32 v2, v11, 1, 3
    v_cmp_eq_u32 vcc, 0, v2
    v_cndmask_b32 v132, 0, v1, vcc
    v_cmp_eq_u32 vcc, 1, v2
    v_cndmask_b32 v133, 0, v1, vcc
    v_cmp_eq_u32 vcc, 2, v2
    v_cndmask_b32 v134, 0, v1, vcc
    v_cmp_eq_u32 vcc, 3, v2
    v_cndmask_b32 v135, 0, v1, vcc
    s_waitcnt vmcnt(9)
    s_barrier
    s_mov_b32 s78, 1
    s_mul_i32 s65, s78, 256
    s_add_u32 m0, s64, 90112
    s_nop 0
    buffer_load_dwordx4 v46, s[40:43], s65 offen  lds
    s_add_u32 m0, s64, 94208
    s_add_u32 s65, s65, 20480
    buffer_load_dwordx4 v46, s[40:43], s65 offen  lds
    s_add_u32 m0, s64, 98304
    s_add_u32 s65, s65, 20480
    buffer_load_dwordx4 v46, s[40:43], s65 offen  lds
    s_add_u32 m0, s64, 102400
    s_add_u32 s65, s65, 20480
    buffer_load_dwordx4 v46, s[40:43], s65 offen  lds
    s_mul_i32 s66, s78, 163840
    s_add_u32 m0, s64, 106496
    s_nop 0
    buffer_load_dwordx4 v47, s[44:47], s66 offen lds
    s_add_u32 m0, s64, 110592
    s_nop 0
    buffer_load_dwordx4 v48, s[44:47], s66 offen lds
    s_add_u32 m0, s64, 114688
    s_nop 0
    buffer_load_dwordx4 v49, s[44:47], s66 offen lds
    s_add_u32 m0, s64, 118784
    s_nop 0
    buffer_load_dwordx4 v50, s[44:47], s66 offen lds
    s_add_u32 m0, s64, 122880
    s_nop 0
    buffer_load_dwordx4 v51, s[44:47], s66 offen lds
    s_mov_b32 s78, 2
    s_mul_i32 s65, s78, 256
    s_add_u32 m0, s64, 126976
    s_nop 0
    buffer_load_dwordx4 v46, s[40:43], s65 offen  lds
    s_add_u32 m0, s64, 131072
    s_add_u32 s65, s65, 20480
    buffer_load_dwordx4 v46, s[40:43], s65 offen  lds
    s_add_u32 m0, s64, 135168
    s_add_u32 s65, s65, 20480
    buffer_load_dwordx4 v46, s[40:43], s65 offen  lds
    s_add_u32 m0, s64, 139264
    s_add_u32 s65, s65, 20480
    buffer_load_dwordx4 v46, s[40:43], s65 offen  lds
    s_mul_i32 s66, s78, 163840
    s_add_u32 m0, s64, 143360
    s_nop 0
    buffer_load_dwordx4 v47, s[44:47], s66 offen lds
    s_add_u32 m0, s64, 147456
    s_nop 0
    buffer_load_dwordx4 v48, s[44:47], s66 offen lds
    s_add_u32 m0, s64, 151552
    s_nop 0
    buffer_load_dwordx4 v49, s[44:47], s66 offen lds
    s_add_u32 m0, s64, 155648
    s_nop 0
    buffer_load_dwordx4 v50, s[44:47], s66 offen lds
    s_add_u32 m0, s64, 159744
    s_nop 0
    buffer_load_dwordx4 v51, s[44:47], s66 offen lds
    s_waitcnt vmcnt(18)
    s_barrier
    s_mov_b32 s78, 3
    s_mul_i32 s65, s78, 256
    s_add_u32 m0, s64, 16384
    s_nop 0
    buffer_load_dwordx4 v46, s[40:43], s65 offen  lds
    s_add_u32 m0, s64, 20480
    s_add_u32 s65, s65, 20480
    buffer_load_dwordx4 v46, s[40:43], s65 offen  lds
    s_add_u32 m0, s64, 24576
    s_add_u32 s65, s65, 20480
    buffer_load_dwordx4 v46, s[40:43], s65 offen  lds
    s_add_u32 m0, s64, 28672
    s_add_u32 s65, s65, 20480
    buffer_load_dwordx4 v46, s[40:43], s65 offen  lds
    s_mul_i32 s66, s78, 163840
    s_add_u32 m0, s64, 32768
    s_nop 0
    buffer_load_dwordx4 v47, s[44:47], s66 offen lds
    s_add_u32 m0, s64, 36864
    s_nop 0
    buffer_load_dwordx4 v48, s[44:47], s66 offen lds
    s_add_u32 m0, s64, 40960
    s_nop 0
    buffer_load_dwordx4 v49, s[44:47], s66 offen lds
    s_add_u32 m0, s64, 45056
    s_nop 0
    buffer_load_dwordx4 v50, s[44:47], s66 offen lds
    s_add_u32 m0, s64, 49152
    s_nop 0
    buffer_load_dwordx4 v51, s[44:47], s66 offen lds
    s_waitcnt vmcnt(18)
    s_barrier
    s_mov_b32 s78, 4
    s_mul_i32 s65, s78, 256
    s_add_u32 m0, s64, 53248
    s_nop 0
    buffer_load_dwordx4 v46, s[40:43], s65 offen  lds
    s_add_u32 m0, s64, 57344
    s_add_u32 s65, s65, 20480
    buffer_load_dwordx4 v46, s[40:43], s65 offen  lds
    s_add_u32 m0, s64, 61440
    s_add_u32 s65, s65, 20480
    buffer_load_dwordx4 v46, s[40:43], s65 offen  lds
    s_add_u32 m0, s64, 65536
    s_add_u32 s65, s65, 20480
    buffer_load_dwordx4 v46, s[40:43], s65 offen  lds
    s_mul_i32 s66, s78, 163840
    s_add_u32 m0, s64, 69632
    s_nop 0
    buffer_load_dwordx4 v47, s[44:47], s66 offen lds
    s_add_u32 m0, s64, 73728
    s_nop 0
    buffer_load_dwordx4 v48, s[44:47], s66 offen lds
    s_add_u32 m0, s64, 77824
    s_nop 0
    buffer_load_dwordx4 v49, s[44:47], s66 offen lds
    s_add_u32 m0, s64, 81920
    s_nop 0
    buffer_load_dwordx4 v50, s[44:47], s66 offen lds
    s_add_u32 m0, s64, 86016
    s_nop 0
    buffer_load_dwordx4 v51, s[44:47], s66 offen lds
    s_waitcnt vmcnt(18)
    s_barrier
    s_waitcnt vmcnt(9)
    s_barrier
    s_mov_b64 exec, 1
    buffer_load_dword v30, v34, s[8:11], s7 offen sc1
    s_mov_b64 exec, -1
    s_waitcnt vmcnt(1)
    s_barrier
    s_waitcnt vmcnt(0)
    v_readfirstlane_b32 s72, v30
    s_nop 3
    s_cmp_eq_u32 s72, 0
    s_cbranch_scc1 p1_37
    buffer_load_dwordx2 v[32:33], v34, s[56:59], 0 offen
    s_mov_b32 s65, s64
    s_and_b32 s14, s12, 7
    s_mul_i32 s14, s14, 20480
    s_add_u32 s14, s14, s64
    s_mov_b32 m0, s65
    s_add_u32 s65, s65, 4096
    buffer_load_dwordx4 v10, s[48:51], s14 offen lds
    s_add_u32 s14, s14, 4096
    s_mov_b32 m0, s65
    s_add_u32 s65, s65, 4096
    buffer_load_dwordx4 v10, s[48:51], s14 offen lds
    s_add_u32 s14, s14, 4096
    s_mov_b32 m0, s65
    s_add_u32 s65, s65, 4096
    buffer_load_dwordx4 v10, s[48:51], s14 offen lds
    s_add_u32 s14, s14, 4096
    s_mov_b32 m0, s65
    s_add_u32 s65, s65, 4096
    buffer_load_dwordx4 v10, s[48:51], s14 offen lds
    s_add_u32 s14, s14, 4096
    s_mov_b32 m0, s65
    s_add_u32 s65, s65, 4096
    buffer_load_dwordx4 v10, s[48:51], s14 offen lds
    s_add_u32 s14, s14, 4096
    s_cmp_ge_u32 s14, 163840
    s_cselect_b32 s72, 163840, 0
    s_sub_u32 s14, s14, s72
    s_mov_b32 m0, s65
    s_add_u32 s65, s65, 4096
    buffer_load_dwordx4 v10, s[48:51], s14 offen lds
    s_add_u32 s14, s14, 4096
    s_mov_b32 m0, s65
    s_add_u32 s65, s65, 4096
    buffer_load_dwordx4 v10, s[48:51], s14 offen lds
    s_add_u32 s14, s14, 4096
    s_mov_b32 m0, s65
    s_add_u32 s65, s65, 4096
    buffer_load_dwordx4 v10, s[48:51], s14 offen lds
    s_add_u32 s14, s14, 4096
    s_mov_b32 m0, s65
    s_add_u32 s65, s65, 4096
    buffer_load_dwordx4 v10, s[48:51], s14 offen lds
    s_add_u32 s14, s14, 4096
    s_mov_b32 m0, s65
    s_add_u32 s65, s65, 4096
    buffer_load_dwordx4 v10, s[48:51], s14 offen lds
    s_add_u32 s14, s14, 4096
    s_cmp_ge_u32 s14, 163840
    s_cselect_b32 s72, 163840, 0
    s_sub_u32 s14, s14, s72
    s_mov_b32 m0, s65
    s_add_u32 s65, s65, 4096
    buffer_load_dwordx4 v10, s[48:51], s14 offen lds
    s_add_u32 s14, s14, 4096
    s_mov_b32 m0, s65
    s_add_u32 s65, s65, 4096
    buffer_load_dwordx4 v10, s[48:51], s14 offen lds
    s_add_u32 s14, s14, 4096
    s_mov_b32 m0, s65
    s_add_u32 s65, s65, 4096
    buffer_load_dwordx4 v10, s[48:51], s14 offen lds
    s_add_u32 s14, s14, 4096
    s_barrier
    s_branch p1_38
p1_37:
    s_mov_b64 exec, 1
    buffer_load_dword v30, v34, s[8:11], s7 offen sc1
    s_mov_b64 exec, -1
    s_barrier
    s_mov_b32 s71, 0x20000
    s_branch p1_41
p1_39:
    s_sub_u32 s71, s71, 1
    s_cmp_eq_u32 s71, 0
    s_cbranch_scc1 p1_40
    s_mov_b64 exec, 1
    buffer_load_dword v30, v34, s[8:11], s7 offen sc1
    s_mov_b64 exec, -1
p1_41:
    s_waitcnt vmcnt(0)
    v_readfirstlane_b32 s72, v30
    s_nop 3
    s_cmp_eq_u32 s72, 0
    s_cbranch_scc1 p1_39
p1_40:
    buffer_load_dwordx2 v[32:33], v34, s[56:59], 0 offen
    s_mov_b32 s65, s64
    s_and_b32 s14, s12, 7
    s_mul_i32 s14, s14, 20480
    s_add_u32 s14, s14, s64
    s_mov_b32 m0, s65
    s_add_u32 s65, s65, 4096
    buffer_load_dwordx4 v10, s[48:51], s14 offen lds
    s_add_u32 s14, s14, 4096
    s_mov_b32 m0, s65
    s_add_u32 s65, s65, 4096
    buffer_load_dwordx4 v10, s[48:51], s14 offen lds
    s_add_u32 s14, s14, 4096
    s_mov_b32 m0, s65
    s_add_u32 s65, s65, 4096
    buffer_load_dwordx4 v10, s[48:51], s14 offen lds
    s_add_u32 s14, s14, 4096
    s_mov_b32 m0, s65
    s_add_u32 s65, s65, 4096
    buffer_load_dwordx4 v10, s[48:51], s14 offen lds
    s_add_u32 s14, s14, 4096
    s_mov_b32 m0, s65
    s_add_u32 s65, s65, 4096
    buffer_load_dwordx4 v10, s[48:51], s14 offen lds
    s_add_u32 s14, s14, 4096
    s_cmp_ge_u32 s14, 163840
    s_cselect_b32 s72, 163840, 0
    s_sub_u32 s14, s14, s72
    s_mov_b32 m0, s65
    s_add_u32 s65, s65, 4096
    buffer_load_dwordx4 v10, s[48:51], s14 offen lds
    s_add_u32 s14, s14, 4096
    s_mov_b32 m0, s65
    s_add_u32 s65, s65, 4096
    buffer_load_dwordx4 v10, s[48:51], s14 offen lds
    s_add_u32 s14, s14, 4096
    s_mov_b32 m0, s65
    s_add_u32 s65, s65, 4096
    buffer_load_dwordx4 v10, s[48:51], s14 offen lds
    s_add_u32 s14, s14, 4096
    s_mov_b32 m0, s65
    s_add_u32 s65, s65, 4096
    buffer_load_dwordx4 v10, s[48:51], s14 offen lds
    s_add_u32 s14, s14, 4096
    s_mov_b32 m0, s65
    s_add_u32 s65, s65, 4096
    buffer_load_dwordx4 v10, s[48:51], s14 offen lds
    s_add_u32 s14, s14, 4096
    s_cmp_ge_u32 s14, 163840
    s_cselect_b32 s72, 163840, 0
    s_sub_u32 s14, s14, s72
    s_mov_b32 m0, s65
    s_add_u32 s65, s65, 4096
    buffer_load_dwordx4 v10, s[48:51], s14 offen lds
    s_add_u32 s14, s14, 4096
    s_mov_b32 m0, s65
    s_add_u32 s65, s65, 4096
    buffer_load_dwordx4 v10, s[48:51], s14 offen lds
    s_add_u32 s14, s14, 4096
    s_mov_b32 m0, s65
    s_add_u32 s65, s65, 4096
    buffer_load_dwordx4 v10, s[48:51], s14 offen lds
    s_add_u32 s14, s14, 4096
p1_38:
    s_barrier
    s_waitcnt vmcnt(13)
    v_max_f32 v32, v32, v33
    s_nop 1
    v_max_f32_dpp v32, v32, v32 row_shr:1 row_mask:0xf bank_mask:0xf bound_ctrl:0
    s_nop 1
    v_max_f32_dpp v32, v32, v32 row_shr:2 row_mask:0xf bank_mask:0xf bound_ctrl:0
    s_nop 1
    v_max_f32_dpp v32, v32, v32 row_shr:4 row_mask:0xf bank_mask:0xf bound_ctrl:0
    s_nop 1
    v_max_f32_dpp v32, v32, v32 row_shr:8 row_mask:0xf bank_mask:0xf bound_ctrl:0
    s_nop 1
    v_max_f32_dpp v32, v32, v32 row_bcast:15 row_mask:0xa bank_mask:0xf
    s_nop 1
    v_max_f32_dpp v32, v32, v32 row_bcast:31 row_mask:0xc bank_mask:0xf
    v_mov_b32 v30, 112640
    s_mov_b32 exec_lo, 0
    s_brev_b32 exec_hi, 1
    ds_write_b32 v30, v32
    s_mov_b64 exec, -1
    s_and_b32 s64, s67, 3
    s_lshl_b32 s73, s2, 2
    s_add_u32 s73, s73, s64
    s_lshl_b32 s72, s12, 2
    s_add_u32 s12, s72, s64
    s_add_u32 s52, s38, 14716928
    s_addc_u32 s53, s39, 0
    s_mov_b32 s54, 6717440
    s_mov_b32 s55, 0x00020000
    s_waitcnt vmcnt(10) lgkmcnt(0)
    s_barrier
    s_waitcnt vmcnt(0)
    s_barrier
    s_mov_b32 m0, s65
    s_add_u32 s65, s65, 4096
    buffer_load_dwordx4 v10, s[48:51], s14 offen lds
    s_add_u32 s14, s14, 4096
    s_mov_b32 m0, s65
    s_add_u32 s65, s65, 4096
    buffer_load_dwordx4 v10, s[48:51], s14 offen lds
    s_add_u32 s14, s14, 4096
    s_cmp_ge_u32 s14, 163840
    s_cselect_b32 s72, 163840, 0
    s_sub_u32 s14, s14, s72
    s_mov_b32 m0, s65
    s_add_u32 s65, s65, 4096
    buffer_load_dwordx4 v10, s[48:51], s14 offen lds
    s_add_u32 s14, s14, 4096
    s_mov_b32 m0, s65
    s_add_u32 s65, s65, 4096
    buffer_load_dwordx4 v10, s[48:51], s14 offen lds
    s_add_u32 s14, s14, 4096
    s_mov_b32 m0, s65
    s_add_u32 s65, s65, 4096
    buffer_load_dwordx4 v10, s[48:51], s14 offen lds
    s_add_u32 s14, s14, 4096
    s_mov_b32 m0, s65
    s_add_u32 s65, s65, 4096
    buffer_load_dwordx4 v10, s[48:51], s14 offen lds
    s_add_u32 s14, s14, 4096
    s_mov_b32 m0, s65
    s_add_u32 s65, s65, 4096
    buffer_load_dwordx4 v10, s[48:51], s14 offen lds
    s_add_u32 s14, s14, 4096
    s_cmp_ge_u32 s14, 163840
    s_cselect_b32 s72, 163840, 0
    s_sub_u32 s14, s14, s72
    s_mov_b32 m0, s65
    s_add_u32 s65, s65, 4096
    buffer_load_dwordx4 v10, s[48:51], s14 offen lds
    s_add_u32 s14, s14, 4096
    s_mov_b32 m0, s65
    s_add_u32 s65, s65, 4096
    buffer_load_dwordx4 v10, s[48:51], s14 offen lds
    s_add_u32 s14, s14, 4096
    s_mov_b32 m0, s65
    s_add_u32 s65, s65, 4096
    buffer_load_dwordx4 v10, s[48:51], s14 offen lds
    s_add_u32 s14, s14, 4096
    s_mov_b32 m0, s65
    s_add_u32 s65, s65, 4096
    buffer_load_dwordx4 v10, s[48:51], s14 offen lds
    s_add_u32 s14, s14, 4096
    s_mov_b32 m0, s65
    s_add_u32 s65, s65, 4096
    buffer_load_dwordx4 v10, s[48:51], s14 offen lds
    s_add_u32 s14, s14, 4096
    s_cmp_ge_u32 s14, 163840
    s_cselect_b32 s72, 163840, 0
    s_sub_u32 s14, s14, s72
    s_mov_b32 m0, s65
    s_add_u32 s65, s65, 4096
    buffer_load_dwordx4 v10, s[48:51], s14 offen lds
    s_add_u32 s14, s14, 4096
    s_mov_b32 m0, s65
    s_add_u32 s65, s65, 4096
    buffer_load_dwordx4 v10, s[48:51], s14 offen lds
    s_add_u32 s14, s14, 4096
    s_mov_b32 m0, s65
    s_add_u32 s65, s65, 4096
    buffer_load_dwordx4 v10, s[48:51], s14 offen lds
    s_add_u32 s14, s14, 4096
    s_mov_b32 m0, s65
    s_add_u32 s65, s65, 4096
    buffer_load_dwordx4 v10, s[48:51], s14 offen lds
    s_add_u32 s14, s14, 4096
    s_mov_b32 m0, s65
    s_add_u32 s65, s65, 4096
    buffer_load_dwordx4 v10, s[48:51], s14 offen lds
    s_add_u32 s14, s14, 4096
    s_cmp_ge_u32 s14, 163840
    s_cselect_b32 s72, 163840, 0
    s_sub_u32 s14, s14, s72
    s_mov_b32 m0, s65
    s_add_u32 s65, s65, 4096
    buffer_load_dwordx4 v10, s[48:51], s14 offen lds
    s_add_u32 s14, s14, 4096
    s_mov_b32 m0, s65
    s_add_u32 s65, s65, 4096
    buffer_load_dwordx4 v10, s[48:51], s14 offen lds
    s_add_u32 s14, s14, 4096
    s_mov_b32 m0, s65
    s_add_u32 s65, s65, 4096
    buffer_load_dwordx4 v10, s[48:51], s14 offen lds
    s_add_u32 s14, s14, 4096
    s_mov_b32 m0, s65
    s_add_u32 s65, s65, 4096
    buffer_load_dwordx4 v10, s[48:51], s14 offen lds
    s_add_u32 s14, s14, 4096
    s_mov_b32 m0, s65
    s_add_u32 s65, s65, 4096
    buffer_load_dwordx4 v10, s[48:51], s14 offen lds
    s_add_u32 s14, s14, 4096
    s_cmp_ge_u32 s14, 163840
    s_cselect_b32 s72, 163840, 0
    s_sub_u32 s14, s14, s72
    s_mov_b32 m0, s65
    s_add_u32 s65, s65, 4096
    buffer_load_dwordx4 v10, s[48:51], s14 offen lds
    s_add_u32 s14, s14, 4096
    s_mov_b32 m0, s65
    s_add_u32 s65, s65, 4096
    buffer_load_dwordx4 v10, s[48:51], s14 offen lds
    s_add_u32 s14, s14, 4096
    s_mov_b32 m0, s65
    s_add_u32 s65, s65, 4096
    buffer_load_dwordx4 v10, s[48:51], s14 offen lds
    s_add_u32 s14, s14, 4096
    s_mov_b32 m0, s65
    s_add_u32 s65, s65, 4096
    buffer_load_dwordx4 v10, s[48:51], s14 offen lds
    s_add_u32 s14, s14, 4096
    s_mov_b32 m0, s65
    s_add_u32 s65, s65, 4096
    buffer_load_dwordx4 v10, s[48:51], s14 offen lds
    s_add_u32 s14, s14, 4096
    s_cmp_ge_u32 s14, 163840
    s_cselect_b32 s72, 163840, 0
    s_sub_u32 s14, s14, s72
    s_cmp_lg_u32 s73, 0
    s_cbranch_scc1 fc_42
    s_mov_b32 s60, s36
    s_mov_b32 s61, s37
    s_mov_b32 s62, 256
    s_mov_b32 s63, 0x00020000
    s_mov_b64 exec, 1
    v_mov_b32 v1, 0
    buffer_store_dword v1, v1, s[60:63], 0 offen offset:128 sc1
    s_mov_b64 exec, -1
fc_42:
    s_cmp_lg_u32 s67, 4
    s_cbranch_scc1 zw_43
    v_mov_b32 v1, 0
    ds_write2_b32 v1, v1, v1 offset0:0 offset1:1
zw_43:
    s_mov_b32 s70, s73
    s_mul_i32 s71, s70, 52429
    s_lshr_b32 s71, s71, 22
    s_mul_i32 s66, s71, 80
    s_sub_u32 s72, s70, s66
    s_mul_i32 s71, s71, 192
    s_lshr_b32 s66, s72, 3
    s_lshl_b32 s66, s66, 2
    s_and_b32 s65, s72, 3
    s_add_u32 s66, s66, s65
    s_mul_i32 s66, s66, 49152
    s_add_u32 s71, s71, s66
    s_bitcmp1_b32 s72, 2
    s_cselect_b32 s40, s30, s28
    s_cselect_b32 s41, s31, s29
    s_mov_b32 s42, 1966080
    buffer_load_dwordx4 v[16:19], v141, s[40:43], s71 offen
    buffer_load_dwordx4 v[20:23], v142, s[40:43], s71 offen
    buffer_load_dwordx4 v[24:27], v143, s[40:43], s71 offen
    s_cmp_lt_u32 s73, 544
    s_cbranch_scc1 k2_rpa
    s_add_u32 s70, s73, 480
    s_cmp_ge_u32 s70, 1280
    s_cbranch_scc1 k2_rpe
    s_mul_i32 s71, s70, 52429
    s_lshr_b32 s71, s71, 22
    s_mul_i32 s66, s71, 80
    s_sub_u32 s72, s70, s66
    s_mul_i32 s71, s71, 192
    s_lshr_b32 s66, s72, 3
    s_lshl_b32 s66, s66, 2
    s_and_b32 s65, s72, 3
    s_add_u32 s66, s66, s65
    s_mul_i32 s66, s66, 49152
    s_add_u32 s71, s71, s66
    s_bitcmp1_b32 s72, 2
    s_cselect_b32 s40, s30, s28
    s_cselect_b32 s41, s31, s29
    s_mov_b32 s42, 1966080
    buffer_load_dwordx4 v[28:31], v141, s[40:43], s71 offen
    buffer_load_dwordx4 v[32:35], v142, s[40:43], s71 offen
    buffer_load_dwordx4 v[36:39], v143, s[40:43], s71 offen
    s_waitcnt vmcnt(6)
    ds_write_b32 v145, v146
    s_waitcnt vmcnt(0)
    s_mul_i32 s66, s70, 3072
    s_add_u32 s66, s66, 2785280
    buffer_store_dwordx4 v[28:31], v10, s[52:55], s66 offen offset:0 sc1
    buffer_store_dwordx4 v[32:35], v10, s[52:55], s66 offen offset:1024 sc1
    buffer_store_dwordx4 v[36:39], v10, s[52:55], s66 offen offset:2048 sc1
    s_branch k2_rpf
k2_rpa:
    s_cmp_ge_u32 s73, 160
    s_cbranch_scc1 ra_44
    s_mul_i32 s71, s73, 3277
    s_lshr_b32 s71, s71, 16
    s_mul_i32 s66, s71, 20
    s_sub_u32 s66, s73, s66
    s_mov_b32 s40, s24
    s_mov_b32 s41, s25
    s_mov_b32 s42, 819200
    s_branch ra_45
ra_44:
    s_sub_u32 s70, s73, 160
    s_mul_i32 s71, s70, 1366
    s_lshr_b32 s71, s71, 16
    s_mul_i32 s66, s71, 48
    s_sub_u32 s66, s70, s66
    s_mov_b32 s40, s32
    s_mov_b32 s41, s33
    s_mov_b32 s42, 1966080
ra_45:
    s_mul_i32 s71, s71, 160
    s_mul_i32 s66, s66, 40960
    s_add_u32 s71, s71, s66
    buffer_load_dwordx4 v[40:43], v136, s[40:43], s71 offen
    buffer_load_dwordx4 v[44:47], v137, s[40:43], s71 offen
    buffer_load_dwordx4 v[48:51], v138, s[40:43], s71 offen
    buffer_load_dwordx4 v[52:55], v139, s[40:43], s71 offen
    buffer_load_dwordx4 v[56:59], v140, s[40:43], s71 offen
    s_mul_i32 s66, s73, 5120
    s_waitcnt vmcnt(8)
    ds_write_b32 v145, v146
    s_waitcnt vmcnt(0)
    buffer_store_dwordx4 v[40:43], v10, s[52:55], s66 offen offset:0 sc1
    buffer_store_dwordx4 v[44:47], v10, s[52:55], s66 offen offset:1024 sc1
    buffer_store_dwordx4 v[48:51], v10, s[52:55], s66 offen offset:2048 sc1
    buffer_store_dwordx4 v[52:55], v10, s[52:55], s66 offen offset:3072 sc1
    s_add_u32 s66, s66, 4096
    buffer_store_dwordx4 v[56:59], v10, s[52:55], s66 offen offset:0 sc1
    s_branch k2_rpf
k2_rpe:
    s_waitcnt vmcnt(3)
    ds_write_b32 v145, v146
    s_waitcnt vmcnt(0)
k2_rpf:
    s_mov_b32 s70, s73
    s_mul_i32 s66, s70, 3072
    s_add_u32 s66, s66, 2785280
    buffer_store_dwordx4 v[16:19], v10, s[52:55], s66 offen offset:0 sc1
    buffer_store_dwordx4 v[20:23], v10, s[52:55], s66 offen offset:1024 sc1
    buffer_store_dwordx4 v[24:27], v10, s[52:55], s66 offen offset:2048 sc1
    s_mov_b64 exec, 1
    v_mov_b32 v1, 0
    v_mov_b32 v2, 1
    s_and_b32 s71, s2, 15
    s_lshl_b32 s71, s71, 8
    s_add_u32 s71, s71, 28672
kw_46:
    s_sleep 1
    ds_read_b128 v[60:63], v1 offset:16
    s_waitcnt lgkmcnt(0)
    v_and_b32 v60, v60, v61
    v_and_b32 v62, v62, v63
    v_and_b32 v60, v60, v62
    s_nop 0
    v_readfirstlane_b32 s72, v60
    s_nop 3
    s_cmp_lg_u32 s72, -1
    s_cbranch_scc1 kw_46
    s_waitcnt vmcnt(0)
    ds_add_rtn_u32 v3, v1, v2 offset:4
    s_waitcnt lgkmcnt(0)
    v_readfirstlane_b32 s15, v3
    s_nop 3
    s_cmp_lg_u32 s15, 3
    s_cbranch_scc1 k2_lw
    v_mov_b32 v3, 1
    s_waitcnt vmcnt(0)
    buffer_atomic_add v3, v1, s[8:11], s71 offen sc0 sc1
    s_waitcnt vmcnt(0)
    v_readfirstlane_b32 s72, v3
    v_mov_b32 v3, 1
    s_mov_b32 s71, 16384
    s_nop 2
    s_cmp_lg_u32 s72, 15
    s_cbranch_scc1 k2_lw
    buffer_atomic_add v3, v1, s[8:11], s71 offen sc0 sc1
    s_waitcnt vmcnt(0)
    v_readfirstlane_b32 s72, v3
    s_nop 3
    s_cmp_lg_u32 s72, 15
    s_cbranch_scc1 k2_lw
    s_mov_b64 exec, 0xff
    v_lshlrev_b32 v4, 8, v11
    v_mov_b32 v3, 1
    buffer_store_dword v3, v4, s[8:11], s71 offen offset:2048 sc1
k2_lw:
    s_mov_b64 exec, -1
    s_cmp_lt_u32 s73, 640
    s_cbranch_scc1 k2_ncs
    s_sub_u32 s72, s73, 640
    s_mul_i32 s70, s72, 1366
    s_lshr_b32 s70, s70, 16
    s_mul_i32 s71, s70, 48
    s_sub_u32 s71, s72, s71
    s_cmp_lt_u32 s71, 24
    s_cselect_b32 s40, s28, s30
    s_cselect_b32 s41, s29, s31
    s_mov_b32 s42, 1966080
    s_cselect_b32 s66, 0, 24
    s_sub_u32 s71, s71, s66
    s_lshl_b32 s71, s71, 7
    s_mul_i32 s70, s70, 245760
    s_add_u32 s71, s71, s70
    buffer_load_dwordx4 v[64:67], v147, s[40:43], s71 offen
    s_add_u32 s71, s71, 24576
    buffer_load_dwordx4 v[68:71], v147, s[40:43], s71 offen
    s_add_u32 s71, s71, 24576
    buffer_load_dwordx4 v[72:75], v147, s[40:43], s71 offen
    s_add_u32 s71, s71, 24576
    buffer_load_dwordx4 v[76:79], v147, s[40:43], s71 offen
    s_add_u32 s71, s71, 24576
    buffer_load_dwordx4 v[80:83], v147, s[40:43], s71 offen
    s_add_u32 s71, s71, 24576
    buffer_load_dwordx4 v[84:87], v147, s[40:43], s71 offen
    s_add_u32 s71, s71, 24576
    buffer_load_dwordx4 v[88:91], v147, s[40:43], s71 offen
    s_add_u32 s71, s71, 24576
    buffer_load_dwordx4 v[92:95], v147, s[40:43], s71 offen
    s_add_u32 s71, s71, 24576
    buffer_load_dwordx4 v[96:99], v147, s[40:43], s71 offen
    s_add_u32 s71, s71, 24576
    buffer_load_dwordx4 v[100:103], v147, s[40:43], s71 offen
    s_add_u32 s71, s71, 24576
    s_add_u32 s56, s38, 2887680
    s_addc_u32 s57, s39, 0
    s_mov_b32 s58, 98304
    s_mov_b32 s59, 0x00020000
    s_lshl_b32 s72, s72, 8
    s_waitcnt vmcnt(9)
    v_mfma_f32_16x16x32_bf16 v[104:107], v[132:135], v[64:67], 0
    s_waitcnt vmcnt(8)
    v_mfma_f32_16x16x32_bf16 v[104:107], v[132:135], v[68:71], v[104:107]
    s_waitcnt vmcnt(7)
    v_mfma_f32_16x16x32_bf16 v[104:107], v[132:135], v[72:75], v[104:107]
    s_waitcnt vmcnt(6)
    v_mfma_f32_16x16x32_bf16 v[104:107], v[132:135], v[76:79], v[104:107]
    s_waitcnt vmcnt(5)
    v_mfma_f32_16x16x32_bf16 v[104:107], v[132:135], v[80:83], v[104:107]
    s_waitcnt vmcnt(4)
    v_mfma_f32_16x16x32_bf16 v[104:107], v[132:135], v[84:87], v[104:107]
    s_waitcnt vmcnt(3)
    v_mfma_f32_16x16x32_bf16 v[104:107], v[132:135], v[88:91], v[104:107]
    s_waitcnt vmcnt(2)
    v_mfma_f32_16x16x32_bf16 v[104:107], v[132:135], v[92:95], v[104:107]
    s_waitcnt vmcnt(1)
    v_mfma_f32_16x16x32_bf16 v[104:107], v[132:135], v[96:99], v[104:107]
    s_waitcnt vmcnt(0)
    v_mfma_f32_16x16x32_bf16 v[104:107], v[132:135], v[100:103], v[104:107]
    s_nop 7
    s_nop 7
    v_add_f32_dpp v104, v104, v104 row_ror:8 row_mask:0xf bank_mask:0xf
    v_add_f32_dpp v105, v105, v105 row_ror:8 row_mask:0xf bank_mask:0xf
    v_add_f32_dpp v106, v106, v106 row_ror:8 row_mask:0xf bank_mask:0xf
    v_add_f32_dpp v107, v107, v107 row_ror:8 row_mask:0xf bank_mask:0xf
    s_mov_b64 exec, 0x00ff00ff
    buffer_store_dwordx4 v[104:107], v148, s[56:59], s72 offen sc1
    s_mov_b64 exec, 1
    v_mov_b32 v1, 0
    s_and_b32 s71, s73, 15
    s_lshl_b32 s71, s71, 8
    s_add_u32 s71, s71, 24580
    v_mov_b32 v3, 1
    s_waitcnt vmcnt(0)
    buffer_atomic_add v3, v1, s[8:11], s71 offen sc0 sc1
    s_waitcnt vmcnt(0)
    v_readfirstlane_b32 s72, v3
    v_mov_b32 v3, 1
    s_mov_b32 s71, 20484
    s_nop 2
    s_cmp_lg_u32 s72, 23
    s_cbranch_scc1 k2_ncs
    buffer_atomic_add v3, v1, s[8:11], s71 offen sc0 sc1
    s_waitcnt vmcnt(0)
    v_readfirstlane_b32 s72, v3
    s_nop 3
    s_cmp_lg_u32 s72, 15
    s_cbranch_scc1 k2_ncs
    s_mov_b64 exec, 0xff
    v_lshlrev_b32 v4, 8, v11
    v_mov_b32 v3, 1
    buffer_store_dword v3, v4, s[8:11], s71 offen offset:2048 sc1
k2_ncs:
    s_mov_b64 exec, 1
    v_mov_b32 v1, 0
    s_cmp_lg_u32 s15, 3
    s_cbranch_scc1 gp_49
    s_lshl_b32 s70, s13, 8
    s_add_u32 s70, s70, 18432
    s_mov_b32 s65, 0x8000
gp_47:
    buffer_load_dword v3, v1, s[8:11], s70 offen sc1
    s_sub_u32 s65, s65, 1
    s_waitcnt vmcnt(0)
    v_readfirstlane_b32 s72, v3
    s_cmp_eq_u32 s65, 0
    s_cbranch_scc1 gp_48
    s_nop 1
    s_cmp_lg_u32 s72, 0
    s_cbranch_scc1 gp_48
    s_sleep 16
    s_branch gp_47
gp_48:
    v_mov_b32 v2, 1
    ds_add_u32 v1, v2
gp_49:
lw_50:
    s_sleep 8
    ds_read_b32 v3, v1
    s_waitcnt lgkmcnt(0)
    v_readfirstlane_b32 s72, v3
    s_nop 3
    s_bitcmp0_b32 s72, 0
    s_cbranch_scc1 lw_50
    s_mov_b64 exec, -1
    s_mul_i32 s71, s12, 6400
    buffer_load_dword v14, v144, s[52:55], s71 offen
    s_sleep 16
    s_mul_i32 s71, s12, 15360
    s_and_b32 s70, s13, 1
    s_mul_i32 s70, s70, 1966080
    s_add_u32 s71, s71, s70
    s_add_u32 s71, s71, 2785280
    buffer_load_dword v14, v144, s[52:55], s71 offen
    s_sleep 16
    s_mul_i32 s71, s12, 15360
    s_and_b32 s70, s13, 1
    s_mul_i32 s70, s70, 1966080
    s_add_u32 s71, s71, s70
    s_add_u32 s71, s71, 2792448
    buffer_load_dword v14, v144, s[52:55], s71 offen
    s_mov_b64 exec, 1
    v_mov_b32 v1, 0
    s_cmp_lg_u32 s15, 3
    s_cbranch_scc1 gp_53
    s_lshl_b32 s70, s13, 8
    s_add_u32 s70, s70, 22532
    s_mov_b32 s65, 0x8000
gp_51:
    buffer_load_dword v3, v1, s[8:11], s70 offen sc1
    s_sub_u32 s65, s65, 1
    s_waitcnt vmcnt(0)
    v_readfirstlane_b32 s72, v3
    s_cmp_eq_u32 s65, 0
    s_cbranch_scc1 gp_52
    s_nop 1
    s_cmp_lg_u32 s72, 0
    s_cbranch_scc1 gp_52
    s_sleep 16
    s_branch gp_51
gp_52:
    v_mov_b32 v2, 2
    ds_add_u32 v1, v2
gp_53:
    s_mov_b64 exec, -1
    v_and_b32 v0, 255, v0
    s_and_b32 s71, s2, 7
    s_lshr_b32 s70, s2, 3
    s_mov_b32 s12, s70
    s_mov_b32 s13, s71
    s_mul_i32 s73, s70, 52
    s_lshr_b32 s73, s73, 8
    s_mul_i32 s73, s73, 5
    s_sub_u32 s73, s70, s73
    s_lshr_b32 s72, s70, 3
    s_lshl_b32 s71, s71, 2
    s_add_u32 s71, s71, s72
    s_lshl_b32 s68, s71, 6
    s_and_b32 s70, s70, 7
    s_mul_i32 s69, s70, 160
    s_add_u32 s40, s38, 3018752
    s_addc_u32 s41, s39, 0
    s_mov_b32 s42, 2621440
    s_mov_b32 s43, 0x00020000
    s_add_u32 s44, s38, 14716928
    s_addc_u32 s45, s39, 0
    s_mov_b32 s46, 6717440
    s_mov_b32 s47, 0x00020000
    s_mul_i32 s14, s70, 102400
    s_add_u32 s48, s38, 5640192
    s_addc_u32 s49, s39, 0
    s_mov_b32 s50, 2621440
    s_mov_b32 s51, 0x00020000
    s_mov_b32 s52, s16
    s_mov_b32 s53, s17
    s_mov_b32 s54, 2621440
    s_mov_b32 s55, 0x00020000
    s_add_u32 s56, s38, 8261632
    s_addc_u32 s57, s39, 0
    s_mov_b32 s58, 131072
    s_mov_b32 s59, 0x00020000
    s_and_b32 s64, s67, 3
    s_lshl_b32 s64, s64, 10
    v_lshrrev_b32 v2, 8, v0
    v_and_b32 v3, 255, v0
    v_lshlrev_b32 v2, 4, v2
    v_add_u32 v2, s68, v2
    v_mul_u32_u24 v2, 1280, v2
    v_lshl_add_u32 v7, v3, 4, v2
    v_lshlrev_b32 v8, 4, v0
    v_mov_b32 v1, 0
lw_54:
    s_sleep 6
    ds_read_b32 v3, v1
    s_waitcnt lgkmcnt(0)
    v_readfirstlane_b32 s72, v3
    s_nop 3
    s_cmp_lt_u32 s72, 0xfe03
    s_cbranch_scc1 lw_54
    s_mov_b32 s78, s73
    s_mul_i32 s66, s78, 20480
    s_add_u32 s66, s66, s14
    s_add_u32 m0, s64, 16384
    s_add_u32 s79, s66, 0
    buffer_load_dwordx4 v8, s[44:47], s79 offen lds
    s_add_u32 m0, s64, 20480
    s_add_u32 s79, s66, 4096
    buffer_load_dwordx4 v8, s[44:47], s79 offen lds
    s_add_u32 m0, s64, 24576
    s_add_u32 s79, s66, 8192
    buffer_load_dwordx4 v8, s[44:47], s79 offen lds
    s_add_u32 m0, s64, 28672
    s_add_u32 s79, s66, 12288
    buffer_load_dwordx4 v8, s[44:47], s79 offen lds
    s_add_u32 m0, s64, 32768
    s_add_u32 s79, s66, 16384
    buffer_load_dwordx4 v8, s[44:47], s79 offen lds
    s_add_u32 s78, s73, 1
    s_sub_u32 s79, s78, 5
    s_cmp_ge_u32 s78, 5
    s_cselect_b32 s78, s79, s78
    s_mul_i32 s66, s78, 20480
    s_add_u32 s66, s66, s14
    s_add_u32 m0, s64, 53248
    s_add_u32 s79, s66, 0
    buffer_load_dwordx4 v8, s[44:47], s79 offen lds
    s_add_u32 m0, s64, 57344
    s_add_u32 s79, s66, 4096
    buffer_load_dwordx4 v8, s[44:47], s79 offen lds
    s_add_u32 m0, s64, 61440
    s_add_u32 s79, s66, 8192
    buffer_load_dwordx4 v8, s[44:47], s79 offen lds
    s_add_u32 m0, s64, 65536
    s_add_u32 s79, s66, 12288
    buffer_load_dwordx4 v8, s[44:47], s79 offen lds
    s_add_u32 m0, s64, 69632
    s_add_u32 s79, s66, 16384
    buffer_load_dwordx4 v8, s[44:47], s79 offen lds
    s_add_u32 s78, s73, 2
    s_sub_u32 s79, s78, 5
    s_cmp_ge_u32 s78, 5
    s_cselect_b32 s78, s79, s78
    s_mul_i32 s66, s78, 20480
    s_add_u32 s66, s66, s14
    s_add_u32 m0, s64, 90112
    s_add_u32 s79, s66, 0
    buffer_load_dwordx4 v8, s[44:47], s79 offen lds
    s_add_u32 m0, s64, 94208
    s_add_u32 s79, s66, 4096
    buffer_load_dwordx4 v8, s[44:47], s79 offen lds
    s_add_u32 m0, s64, 98304
    s_add_u32 s79, s66, 8192
    buffer_load_dwordx4 v8, s[44:47], s79 offen lds
    s_add_u32 m0, s64, 102400
    s_add_u32 s79, s66, 12288
    buffer_load_dwordx4 v8, s[44:47], s79 offen lds
    s_add_u32 m0, s64, 106496
    s_add_u32 s79, s66, 16384
    buffer_load_dwordx4 v8, s[44:47], s79 offen lds
    s_cmp_lt_u32 s67, 6
    s_cbranch_scc1 k4e_55
    s_add_u32 s60, s38, 2887680
    s_addc_u32 s61, s39, 0
    s_mov_b32 s62, 98304
    s_mov_b32 s63, 0x00020000
    s_lshr_b32 s72, s12, 2
    s_and_b32 s71, s13, 1
    s_lshl_b32 s71, s71, 3
    s_add_u32 s72, s72, s71
    s_mul_i32 s72, s72, 384
    v_and_b32 v1, 63, v0
    v_min_u32 v1, 23, v1
    v_lshlrev_b32 v1, 4, v1
    s_sub_u32 s71, s67, 6
    s_mul_i32 s71, s71, 6144
    s_add_u32 s71, s71, s72
    buffer_load_dwordx4 v[104:107], v1, s[60:63], s71 offen
    s_add_u32 s71, s71, 12288
    buffer_load_dwordx4 v[108:111], v1, s[60:63], s71 offen
    s_add_u32 s71, s71, 12288
    buffer_load_dwordx4 v[112:115], v1, s[60:63], s71 offen
    s_add_u32 s71, s71, 12288
    buffer_load_dwordx4 v[116:119], v1, s[60:63], s71 offen
    s_add_u32 s71, s71, 12288
    buffer_load_dwordx4 v[120:123], v1, s[60:63], s71 offen
    s_add_u32 s71, s71, 12288
    buffer_load_dwordx4 v[124:127], v1, s[60:63], s71 offen
    s_add_u32 s71, s71, 12288
    buffer_load_dwordx4 v[128:131], v1, s[60:63], s71 offen
    s_add_u32 s71, s71, 12288
    buffer_load_dwordx4 v[132:135], v1, s[60:63], s71 offen
    s_add_u32 s71, s71, 12288
    s_waitcnt vmcnt(0)
k4e_55:
    s_barrier
    s_barrier
    s_add_u32 s78, s73, 3
    s_sub_u32 s79, s78, 5
    s_cmp_ge_u32 s78, 5
    s_cselect_b32 s78, s79, s78
    s_mul_i32 s66, s78, 20480
    s_add_u32 s66, s66, s14
    s_add_u32 m0, s64, 126976
    s_add_u32 s79, s66, 0
    buffer_load_dwordx4 v8, s[44:47], s79 offen lds
    s_add_u32 m0, s64, 131072
    s_add_u32 s79, s66, 4096
    buffer_load_dwordx4 v8, s[44:47], s79 offen lds
    s_add_u32 m0, s64, 135168
    s_add_u32 s79, s66, 8192
    buffer_load_dwordx4 v8, s[44:47], s79 offen lds
    s_add_u32 m0, s64, 139264
    s_add_u32 s79, s66, 12288
    buffer_load_dwordx4 v8, s[44:47], s79 offen lds
    s_add_u32 m0, s64, 143360
    s_add_u32 s79, s66, 16384
    buffer_load_dwordx4 v8, s[44:47], s79 offen lds
    s_barrier
    s_mov_b32 s78, s73
    s_mul_i32 s65, s78, 4096
    s_add_u32 m0, s64, 0
    s_nop 0
    buffer_load_dwordx4 v7, s[40:43], s65 offen sc1 lds
    s_add_u32 m0, s64, 4096
    s_add_u32 s65, s65, 20480
    buffer_load_dwordx4 v7, s[40:43], s65 offen sc1 lds
    s_add_u32 m0, s64, 8192
    s_add_u32 s65, s65, 20480
    buffer_load_dwordx4 v7, s[40:43], s65 offen sc1 lds
    s_add_u32 m0, s64, 12288
    s_add_u32 s65, s65, 20480
    buffer_load_dwordx4 v7, s[40:43], s65 offen sc1 lds
    s_add_u32 s78, s73, 1
    s_sub_u32 s79, s78, 5
    s_cmp_ge_u32 s78, 5
    s_cselect_b32 s78, s79, s78
    s_mul_i32 s65, s78, 4096
    s_add_u32 m0, s64, 36864
    s_nop 0
    buffer_load_dwordx4 v7, s[40:43], s65 offen sc1 lds
    s_add_u32 m0, s64, 40960
    s_add_u32 s65, s65, 20480
    buffer_load_dwordx4 v7, s[40:43], s65 offen sc1 lds
    s_add_u32 m0, s64, 45056
    s_add_u32 s65, s65, 20480
    buffer_load_dwordx4 v7, s[40:43], s65 offen sc1 lds
    s_add_u32 m0, s64, 49152
    s_add_u32 s65, s65, 20480
    buffer_load_dwordx4 v7, s[40:43], s65 offen sc1 lds
    s_waitcnt vmcnt(4)
    s_barrier
    s_add_u32 s78, s73, 2
    s_sub_u32 s79, s78, 5
    s_cmp_ge_u32 s78, 5
    s_cselect_b32 s78, s79, s78
    s_mul_i32 s65, s78, 4096
    s_add_u32 m0, s64, 73728
    s_nop 0
    buffer_load_dwordx4 v7, s[40:43], s65 offen sc1 lds
    s_add_u32 m0, s64, 77824
    s_add_u32 s65, s65, 20480
    buffer_load_dwordx4 v7, s[40:43], s65 offen sc1 lds
    s_add_u32 m0, s64, 81920
    s_add_u32 s65, s65, 20480
    buffer_load_dwordx4 v7, s[40:43], s65 offen sc1 lds
    s_add_u32 m0, s64, 86016
    s_add_u32 s65, s65, 20480
    buffer_load_dwordx4 v7, s[40:43], s65 offen sc1 lds
    s_add_u32 s78, s73, 3
    s_sub_u32 s79, s78, 5
    s_cmp_ge_u32 s78, 5
    s_cselect_b32 s78, s79, s78
    s_mul_i32 s65, s78, 4096
    s_add_u32 m0, s64, 110592
    s_nop 0
    buffer_load_dwordx4 v7, s[40:43], s65 offen sc1 lds
    s_add_u32 m0, s64, 114688
    s_add_u32 s65, s65, 20480
    buffer_load_dwordx4 v7, s[40:43], s65 offen sc1 lds
    s_add_u32 m0, s64, 118784
    s_add_u32 s65, s65, 20480
    buffer_load_dwordx4 v7, s[40:43], s65 offen sc1 lds
    s_add_u32 m0, s64, 122880
    s_add_u32 s65, s65, 20480
    buffer_load_dwordx4 v7, s[40:43], s65 offen sc1 lds
    s_waitcnt vmcnt(8)
    s_barrier
    s_add_u32 s78, s73, 4
    s_sub_u32 s79, s78, 5
    s_cmp_ge_u32 s78, 5
    s_cselect_b32 s78, s79, s78
    s_mul_i32 s65, s78, 4096
    s_add_u32 m0, s64, 0
    s_nop 0
    buffer_load_dwordx4 v7, s[40:43], s65 offen sc1 lds
    s_add_u32 m0, s64, 4096
    s_add_u32 s65, s65, 20480
    buffer_load_dwordx4 v7, s[40:43], s65 offen sc1 lds
    s_add_u32 m0, s64, 8192
    s_add_u32 s65, s65, 20480
    buffer_load_dwordx4 v7, s[40:43], s65 offen sc1 lds
    s_add_u32 m0, s64, 12288
    s_add_u32 s65, s65, 20480
    buffer_load_dwordx4 v7, s[40:43], s65 offen sc1 lds
    s_mul_i32 s66, s78, 20480
    s_add_u32 s66, s66, s14
    s_add_u32 m0, s64, 16384
    s_add_u32 s79, s66, 0
    buffer_load_dwordx4 v8, s[44:47], s79 offen lds
    s_add_u32 m0, s64, 20480
    s_add_u32 s79, s66, 4096
    buffer_load_dwordx4 v8, s[44:47], s79 offen lds
    s_add_u32 m0, s64, 24576
    s_add_u32 s79, s66, 8192
    buffer_load_dwordx4 v8, s[44:47], s79 offen lds
    s_add_u32 m0, s64, 28672
    s_add_u32 s79, s66, 12288
    buffer_load_dwordx4 v8, s[44:47], s79 offen lds
    s_add_u32 m0, s64, 32768
    s_add_u32 s79, s66, 16384
    buffer_load_dwordx4 v8, s[44:47], s79 offen lds
    s_waitcnt vmcnt(13)
    s_barrier
    s_and_b32 s13, s2, 7
    s_lshr_b32 s12, s2, 3
    s_mul_i32 s73, s12, 26
    s_lshr_b32 s73, s73, 8
    s_mul_i32 s73, s73, 10
    s_sub_u32 s73, s12, s73
    s_lshr_b32 s72, s13, 1
    s_lshl_b32 s72, s72, 2
    s_and_b32 s68, s12, 3
    s_add_u32 s68, s68, s72
    s_lshl_b32 s68, s68, 7
    s_lshr_b32 s72, s12, 2
    s_and_b32 s71, s13, 1
    s_lshl_b32 s71, s71, 3
    s_add_u32 s70, s72, s71
    s_mul_i32 s69, s70, 192
    s_mul_i32 s14, s70, 245760
    s_add_u32 s40, s38, 5640192
    s_addc_u32 s41, s39, 0
    s_mov_b32 s42, 2621440
    s_mov_b32 s43, 0x00020000
    s_add_u32 s44, s38, 14716928
    s_addc_u32 s45, s39, 0
    s_mov_b32 s46, 6717440
    s_mov_b32 s47, 0x00020000
    s_add_u32 s52, s38, 8392704
    s_addc_u32 s53, s39, 0
    s_mov_b32 s54, 6291456
    s_mov_b32 s55, 0x00020000
    s_and_b32 s64, s67, 3
    s_lshl_b32 s64, s64, 10
    v_lshrrev_b32 v2, 7, v0
    v_and_b32 v3, 127, v0
    v_lshlrev_b32 v2, 4, v2
    v_add_u32 v2, s68, v2
    v_mul_u32_u24 v2, 1280, v2
    v_lshl_add_u32 v7, v3, 4, v2
    v_lshlrev_b32 v8, 4, v0
    s_mov_b32 s78, s73
    s_mul_i32 s66, s78, 24576
    s_add_u32 s66, s66, s14
    s_add_u32 m0, s64, 36864
    s_add_u32 s79, s66, 2785280
    buffer_load_dwordx4 v8, s[44:47], s79 offen lds
    s_add_u32 m0, s64, 40960
    s_add_u32 s79, s66, 2789376
    buffer_load_dwordx4 v8, s[44:47], s79 offen lds
    s_add_u32 m0, s64, 45056
    s_add_u32 s79, s66, 2793472
    buffer_load_dwordx4 v8, s[44:47], s79 offen lds
    s_add_u32 m0, s64, 49152
    s_add_u32 s79, s66, 2797568
    buffer_load_dwordx4 v8, s[44:47], s79 offen lds
    s_add_u32 m0, s64, 53248
    s_add_u32 s79, s66, 2801664
    buffer_load_dwordx4 v8, s[44:47], s79 offen lds
    s_add_u32 m0, s64, 57344
    s_add_u32 s79, s66, 2805760
    buffer_load_dwordx4 v8, s[44:47], s79 offen lds
    s_waitcnt vmcnt(15)
    s_barrier
    s_add_u32 s78, s73, 1
    s_sub_u32 s79, s78, 10
    s_cmp_ge_u32 s78, 10
    s_cselect_b32 s78, s79, s78
    s_mul_i32 s66, s78, 24576
    s_add_u32 s66, s66, s14
    s_add_u32 m0, s64, 77824
    s_add_u32 s79, s66, 2785280
    buffer_load_dwordx4 v8, s[44:47], s79 offen lds
    s_add_u32 m0, s64, 81920
    s_add_u32 s79, s66, 2789376
    buffer_load_dwordx4 v8, s[44:47], s79 offen lds
    s_add_u32 m0, s64, 86016
    s_add_u32 s79, s66, 2793472
    buffer_load_dwordx4 v8, s[44:47], s79 offen lds
    s_add_u32 m0, s64, 90112
    s_add_u32 s79, s66, 2797568
    buffer_load_dwordx4 v8, s[44:47], s79 offen lds
    s_add_u32 m0, s64, 94208
    s_add_u32 s79, s66, 2801664
    buffer_load_dwordx4 v8, s[44:47], s79 offen lds
    s_add_u32 m0, s64, 98304
    s_add_u32 s79, s66, 2805760
    buffer_load_dwordx4 v8, s[44:47], s79 offen lds
    s_waitcnt vmcnt(12)
    s_barrier
    s_add_u32 s78, s73, 2
    s_sub_u32 s79, s78, 10
    s_cmp_ge_u32 s78, 10
    s_cselect_b32 s78, s79, s78
    s_mul_i32 s66, s78, 24576
    s_add_u32 s66, s66, s14
    s_add_u32 m0, s64, 118784
    s_add_u32 s79, s66, 2785280
    buffer_load_dwordx4 v8, s[44:47], s79 offen lds
    s_add_u32 m0, s64, 122880
    s_add_u32 s79, s66, 2789376
    buffer_load_dwordx4 v8, s[44:47], s79 offen lds
    s_add_u32 m0, s64, 126976
    s_add_u32 s79, s66, 2793472
    buffer_load_dwordx4 v8, s[44:47], s79 offen lds
    s_add_u32 m0, s64, 131072
    s_add_u32 s79, s66, 2797568
    buffer_load_dwordx4 v8, s[44:47], s79 offen lds
    s_add_u32 m0, s64, 135168
    s_add_u32 s79, s66, 2801664
    buffer_load_dwordx4 v8, s[44:47], s79 offen lds
    s_add_u32 m0, s64, 139264
    s_add_u32 s79, s66, 2805760
    buffer_load_dwordx4 v8, s[44:47], s79 offen lds
    s_barrier
    s_barrier
    s_barrier
    s_mov_b32 s78, s73
    s_mul_i32 s65, s78, 2048
    s_add_u32 m0, s64, 20480
    s_nop 0
    buffer_load_dwordx4 v7, s[40:43], s65 offen sc1 lds
    s_add_u32 m0, s64, 24576
    s_add_u32 s65, s65, 40960
    buffer_load_dwordx4 v7, s[40:43], s65 offen sc1 lds
    s_add_u32 m0, s64, 28672
    s_add_u32 s65, s65, 40960
    buffer_load_dwordx4 v7, s[40:43], s65 offen sc1 lds
    s_add_u32 m0, s64, 32768
    s_add_u32 s65, s65, 40960
    buffer_load_dwordx4 v7, s[40:43], s65 offen sc1 lds
    s_add_u32 s78, s73, 1
    s_sub_u32 s79, s78, 10
    s_cmp_ge_u32 s78, 10
    s_cselect_b32 s78, s79, s78
    s_mul_i32 s65, s78, 2048
    s_add_u32 m0, s64, 61440
    s_nop 0
    buffer_load_dwordx4 v7, s[40:43], s65 offen sc1 lds
    s_add_u32 m0, s64, 65536
    s_add_u32 s65, s65, 40960
    buffer_load_dwordx4 v7, s[40:43], s65 offen sc1 lds
    s_add_u32 m0, s64, 69632
    s_add_u32 s65, s65, 40960
    buffer_load_dwordx4 v7, s[40:43], s65 offen sc1 lds
    s_add_u32 m0, s64, 73728
    s_add_u32 s65, s65, 40960
    buffer_load_dwordx4 v7, s[40:43], s65 offen sc1 lds
    s_waitcnt vmcnt(4)
    s_barrier
    s_add_u32 s78, s73, 2
    s_sub_u32 s79, s78, 10
    s_cmp_ge_u32 s78, 10
    s_cselect_b32 s78, s79, s78
    s_mul_i32 s65, s78, 2048
    s_add_u32 m0, s64, 102400
    s_nop 0
    buffer_load_dwordx4 v7, s[40:43], s65 offen sc1 lds
    s_add_u32 m0, s64, 106496
    s_add_u32 s65, s65, 40960
    buffer_load_dwordx4 v7, s[40:43], s65 offen sc1 lds
    s_add_u32 m0, s64, 110592
    s_add_u32 s65, s65, 40960
    buffer_load_dwordx4 v7, s[40:43], s65 offen sc1 lds
    s_add_u32 m0, s64, 114688
    s_add_u32 s65, s65, 40960
    buffer_load_dwordx4 v7, s[40:43], s65 offen sc1 lds
    s_waitcnt vmcnt(4)
    s_barrier
    s_add_u32 s78, s73, 3
    s_sub_u32 s79, s78, 10
    s_cmp_ge_u32 s78, 10
    s_cselect_b32 s78, s79, s78
    s_mul_i32 s65, s78, 2048
    s_add_u32 m0, s64, 20480
    s_nop 0
    buffer_load_dwordx4 v7, s[40:43], s65 offen sc1 lds
    s_add_u32 m0, s64, 24576
    s_add_u32 s65, s65, 40960
    buffer_load_dwordx4 v7, s[40:43], s65 offen sc1 lds
    s_add_u32 m0, s64, 28672
    s_add_u32 s65, s65, 40960
    buffer_load_dwordx4 v7, s[40:43], s65 offen sc1 lds
    s_add_u32 m0, s64, 32768
    s_add_u32 s65, s65, 40960
    buffer_load_dwordx4 v7, s[40:43], s65 offen sc1 lds
    s_mul_i32 s66, s78, 24576
    s_add_u32 s66, s66, s14
    s_add_u32 m0, s64, 36864
    s_add_u32 s79, s66, 2785280
    buffer_load_dwordx4 v8, s[44:47], s79 offen lds
    s_add_u32 m0, s64, 40960
    s_add_u32 s79, s66, 2789376
    buffer_load_dwordx4 v8, s[44:47], s79 offen lds
    s_add_u32 m0, s64, 45056
    s_add_u32 s79, s66, 2793472
    buffer_load_dwordx4 v8, s[44:47], s79 offen lds
    s_add_u32 m0, s64, 49152
    s_add_u32 s79, s66, 2797568
    buffer_load_dwordx4 v8, s[44:47], s79 offen lds
    s_add_u32 m0, s64, 53248
    s_add_u32 s79, s66, 2801664
    buffer_load_dwordx4 v8, s[44:47], s79 offen lds
    s_add_u32 m0, s64, 57344
    s_add_u32 s79, s66, 2805760
    buffer_load_dwordx4 v8, s[44:47], s79 offen lds
    s_add_u32 s56, s38, 8261632
    s_addc_u32 s57, s39, 0
    s_mov_b32 s58, 131072
    s_mov_b32 s59, 0x00020000
    v_and_b32 v1, 127, v0
    v_add_u32 v1, s68, v1
    v_lshlrev_b32 v1, 3, v1
    s_mov_b32 s71, 0
    buffer_load_dwordx2 v[12:13], v1, s[56:59], s71 offen sc1
    s_mov_b32 s71, 16384
    buffer_load_dwordx2 v[14:15], v1, s[56:59], s71 offen sc1
    s_mov_b32 s71, 32768
    buffer_load_dwordx2 v[16:17], v1, s[56:59], s71 offen sc1
    s_mov_b32 s71, 49152
    buffer_load_dwordx2 v[18:19], v1, s[56:59], s71 offen sc1
    s_mov_b32 s71, 65536
    buffer_load_dwordx2 v[20:21], v1, s[56:59], s71 offen sc1
    s_mov_b32 s71, 81920
    buffer_load_dwordx2 v[22:23], v1, s[56:59], s71 offen sc1
    s_mov_b32 s71, 98304
    buffer_load_dwordx2 v[24:25], v1, s[56:59], s71 offen sc1
    s_mov_b32 s71, 114688
    buffer_load_dwordx2 v[26:27], v1, s[56:59], s71 offen sc1
    s_waitcnt vmcnt(18)
    s_barrier
    s_add_u32 s78, s73, 4
    s_sub_u32 s79, s78, 10
    s_cmp_ge_u32 s78, 10
    s_cselect_b32 s78, s79, s78
    s_mul_i32 s65, s78, 2048
    s_add_u32 m0, s64, 61440
    s_nop 0
    buffer_load_dwordx4 v7, s[40:43], s65 offen sc1 lds
    s_add_u32 m0, s64, 65536
    s_add_u32 s65, s65, 40960
    buffer_load_dwordx4 v7, s[40:43], s65 offen sc1 lds
    s_add_u32 m0, s64, 69632
    s_add_u32 s65, s65, 40960
    buffer_load_dwordx4 v7, s[40:43], s65 offen sc1 lds
    s_add_u32 m0, s64, 73728
    s_add_u32 s65, s65, 40960
    buffer_load_dwordx4 v7, s[40:43], s65 offen sc1 lds
    s_mul_i32 s66, s78, 24576
    s_add_u32 s66, s66, s14
    s_add_u32 m0, s64, 77824
    s_add_u32 s79, s66, 2785280
    buffer_load_dwordx4 v8, s[44:47], s79 offen lds
    s_add_u32 m0, s64, 81920
    s_add_u32 s79, s66, 2789376
    buffer_load_dwordx4 v8, s[44:47], s79 offen lds
    s_add_u32 m0, s64, 86016
    s_add_u32 s79, s66, 2793472
    buffer_load_dwordx4 v8, s[44:47], s79 offen lds
    s_add_u32 m0, s64, 90112
    s_add_u32 s79, s66, 2797568
    buffer_load_dwordx4 v8, s[44:47], s79 offen lds
    s_add_u32 m0, s64, 94208
    s_add_u32 s79, s66, 2801664
    buffer_load_dwordx4 v8, s[44:47], s79 offen lds
    s_add_u32 m0, s64, 98304
    s_add_u32 s79, s66, 2805760
    buffer_load_dwordx4 v8, s[44:47], s79 offen lds
    s_waitcnt vmcnt(18)
    s_barrier
    s_add_u32 s78, s73, 5
    s_sub_u32 s79, s78, 10
    s_cmp_ge_u32 s78, 10
    s_cselect_b32 s78, s79, s78
    s_mul_i32 s65, s78, 2048
    s_add_u32 m0, s64, 102400
    s_nop 0
    buffer_load_dwordx4 v7, s[40:43], s65 offen sc1 lds
    s_add_u32 m0, s64, 106496
    s_add_u32 s65, s65, 40960
    buffer_load_dwordx4 v7, s[40:43], s65 offen sc1 lds
    s_add_u32 m0, s64, 110592
    s_add_u32 s65, s65, 40960
    buffer_load_dwordx4 v7, s[40:43], s65 offen sc1 lds
    s_add_u32 m0, s64, 114688
    s_add_u32 s65, s65, 40960
    buffer_load_dwordx4 v7, s[40:43], s65 offen sc1 lds
    s_mul_i32 s66, s78, 24576
    s_add_u32 s66, s66, s14
    s_add_u32 m0, s64, 118784
    s_add_u32 s79, s66, 2785280
    buffer_load_dwordx4 v8, s[44:47], s79 offen lds
    s_add_u32 m0, s64, 122880
    s_add_u32 s79, s66, 2789376
    buffer_load_dwordx4 v8, s[44:47], s79 offen lds
    s_add_u32 m0, s64, 126976
    s_add_u32 s79, s66, 2793472
    buffer_load_dwordx4 v8, s[44:47], s79 offen lds
    s_add_u32 m0, s64, 131072
    s_add_u32 s79, s66, 2797568
    buffer_load_dwordx4 v8, s[44:47], s79 offen lds
    s_add_u32 m0, s64, 135168
    s_add_u32 s79, s66, 2801664
    buffer_load_dwordx4 v8, s[44:47], s79 offen lds
    s_add_u32 m0, s64, 139264
    s_add_u32 s79, s66, 2805760
    buffer_load_dwordx4 v8, s[44:47], s79 offen lds
    s_waitcnt vmcnt(10)
    s_barrier
    s_add_u32 s78, s73, 6
    s_sub_u32 s79, s78, 10
    s_cmp_ge_u32 s78, 10
    s_cselect_b32 s78, s79, s78
    s_mul_i32 s65, s78, 2048
    s_add_u32 m0, s64, 20480
    s_nop 0
    buffer_load_dwordx4 v7, s[40:43], s65 offen sc1 lds
    s_add_u32 m0, s64, 24576
    s_add_u32 s65, s65, 40960
    buffer_load_dwordx4 v7, s[40:43], s65 offen sc1 lds
    s_add_u32 m0, s64, 28672
    s_add_u32 s65, s65, 40960
    buffer_load_dwordx4 v7, s[40:43], s65 offen sc1 lds
    s_add_u32 m0, s64, 32768
    s_add_u32 s65, s65, 40960
    buffer_load_dwordx4 v7, s[40:43], s65 offen sc1 lds
    s_mul_i32 s66, s78, 24576
    s_add_u32 s66, s66, s14
    s_add_u32 m0, s64, 36864
    s_add_u32 s79, s66, 2785280
    buffer_load_dwordx4 v8, s[44:47], s79 offen lds
    s_add_u32 m0, s64, 40960
    s_add_u32 s79, s66, 2789376
    buffer_load_dwordx4 v8, s[44:47], s79 offen lds
    s_add_u32 m0, s64, 45056
    s_add_u32 s79, s66, 2793472
    buffer_load_dwordx4 v8, s[44:47], s79 offen lds
    s_add_u32 m0, s64, 49152
    s_add_u32 s79, s66, 2797568
    buffer_load_dwordx4 v8, s[44:47], s79 offen lds
    s_add_u32 m0, s64, 53248
    s_add_u32 s79, s66, 2801664
    buffer_load_dwordx4 v8, s[44:47], s79 offen lds
    s_add_u32 m0, s64, 57344
    s_add_u32 s79, s66, 2805760
    buffer_load_dwordx4 v8, s[44:47], s79 offen lds
    s_waitcnt vmcnt(10)
    s_barrier
    s_add_u32 s78, s73, 7
    s_sub_u32 s79, s78, 10
    s_cmp_ge_u32 s78, 10
    s_cselect_b32 s78, s79, s78
    s_mul_i32 s65, s78, 2048
    s_add_u32 m0, s64, 61440
    s_nop 0
    buffer_load_dwordx4 v7, s[40:43], s65 offen sc1 lds
    s_add_u32 m0, s64, 65536
    s_add_u32 s65, s65, 40960
    buffer_load_dwordx4 v7, s[40:43], s65 offen sc1 lds
    s_add_u32 m0, s64, 69632
    s_add_u32 s65, s65, 40960
    buffer_load_dwordx4 v7, s[40:43], s65 offen sc1 lds
    s_add_u32 m0, s64, 73728
    s_add_u32 s65, s65, 40960
    buffer_load_dwordx4 v7, s[40:43], s65 offen sc1 lds
    s_mul_i32 s66, s78, 24576
    s_add_u32 s66, s66, s14
    s_add_u32 m0, s64, 77824
    s_add_u32 s79, s66, 2785280
    buffer_load_dwordx4 v8, s[44:47], s79 offen lds
    s_add_u32 m0, s64, 81920
    s_add_u32 s79, s66, 2789376
    buffer_load_dwordx4 v8, s[44:47], s79 offen lds
    s_add_u32 m0, s64, 86016
    s_add_u32 s79, s66, 2793472
    buffer_load_dwordx4 v8, s[44:47], s79 offen lds
    s_add_u32 m0, s64, 90112
    s_add_u32 s79, s66, 2797568
    buffer_load_dwordx4 v8, s[44:47], s79 offen lds
    s_add_u32 m0, s64, 94208
    s_add_u32 s79, s66, 2801664
    buffer_load_dwordx4 v8, s[44:47], s79 offen lds
    s_add_u32 m0, s64, 98304
    s_add_u32 s79, s66, 2805760
    buffer_load_dwordx4 v8, s[44:47], s79 offen lds
    s_waitcnt vmcnt(10)
    s_barrier
    s_add_u32 s78, s73, 8
    s_sub_u32 s79, s78, 10
    s_cmp_ge_u32 s78, 10
    s_cselect_b32 s78, s79, s78
    s_mul_i32 s65, s78, 2048
    s_add_u32 m0, s64, 102400
    s_nop 0
    buffer_load_dwordx4 v7, s[40:43], s65 offen sc1 lds
    s_add_u32 m0, s64, 106496
    s_add_u32 s65, s65, 40960
    buffer_load_dwordx4 v7, s[40:43], s65 offen sc1 lds
    s_add_u32 m0, s64, 110592
    s_add_u32 s65, s65, 40960
    buffer_load_dwordx4 v7, s[40:43], s65 offen sc1 lds
    s_add_u32 m0, s64, 114688
    s_add_u32 s65, s65, 40960
    buffer_load_dwordx4 v7, s[40:43], s65 offen sc1 lds
    s_mul_i32 s66, s78, 24576
    s_add_u32 s66, s66, s14
    s_add_u32 m0, s64, 118784
    s_add_u32 s79, s66, 2785280
    buffer_load_dwordx4 v8, s[44:47], s79 offen lds
    s_add_u32 m0, s64, 122880
    s_add_u32 s79, s66, 2789376
    buffer_load_dwordx4 v8, s[44:47], s79 offen lds
    s_add_u32 m0, s64, 126976
    s_add_u32 s79, s66, 2793472
    buffer_load_dwordx4 v8, s[44:47], s79 offen lds
    s_add_u32 m0, s64, 131072
    s_add_u32 s79, s66, 2797568
    buffer_load_dwordx4 v8, s[44:47], s79 offen lds
    s_add_u32 m0, s64, 135168
    s_add_u32 s79, s66, 2801664
    buffer_load_dwordx4 v8, s[44:47], s79 offen lds
    s_add_u32 m0, s64, 139264
    s_add_u32 s79, s66, 2805760
    buffer_load_dwordx4 v8, s[44:47], s79 offen lds
    s_waitcnt vmcnt(10)
    s_barrier
    s_add_u32 s78, s73, 9
    s_sub_u32 s79, s78, 10
    s_cmp_ge_u32 s78, 10
    s_cselect_b32 s78, s79, s78
    s_mul_i32 s65, s78, 2048
    s_add_u32 m0, s64, 20480
    s_nop 0
    buffer_load_dwordx4 v7, s[40:43], s65 offen sc1 lds
    s_add_u32 m0, s64, 24576
    s_add_u32 s65, s65, 40960
    buffer_load_dwordx4 v7, s[40:43], s65 offen sc1 lds
    s_add_u32 m0, s64, 28672
    s_add_u32 s65, s65, 40960
    buffer_load_dwordx4 v7, s[40:43], s65 offen sc1 lds
    s_add_u32 m0, s64, 32768
    s_add_u32 s65, s65, 40960
    buffer_load_dwordx4 v7, s[40:43], s65 offen sc1 lds
    s_mul_i32 s66, s78, 24576
    s_add_u32 s66, s66, s14
    s_add_u32 m0, s64, 36864
    s_add_u32 s79, s66, 2785280
    buffer_load_dwordx4 v8, s[44:47], s79 offen lds
    s_add_u32 m0, s64, 40960
    s_add_u32 s79, s66, 2789376
    buffer_load_dwordx4 v8, s[44:47], s79 offen lds
    s_add_u32 m0, s64, 45056
    s_add_u32 s79, s66, 2793472
    buffer_load_dwordx4 v8, s[44:47], s79 offen lds
    s_add_u32 m0, s64, 49152
    s_add_u32 s79, s66, 2797568
    buffer_load_dwordx4 v8, s[44:47], s79 offen lds
    s_add_u32 m0, s64, 53248
    s_add_u32 s79, s66, 2801664
    buffer_load_dwordx4 v8, s[44:47], s79 offen lds
    s_add_u32 m0, s64, 57344
    s_add_u32 s79, s66, 2805760
    buffer_load_dwordx4 v8, s[44:47], s79 offen lds
    s_and_b32 s71, s13, 1
    s_mul_i32 s71, s71, 983040
    s_mul_i32 s72, s12, 30720
    s_add_u32 s71, s71, s72
    s_add_u32 s71, s71, 819200
    v_min_u32 v1, 239, v0
    v_lshlrev_b32 v1, 7, v1
    buffer_load_dword v100, v1, s[44:47], s71 offen
    s_waitcnt vmcnt(11)
    s_barrier
    s_setprio 2
    s_cmp_ge_u32 s67, 6
    s_cbranch_scc1 k4e_56
    v_add_f32 v12, v12, v14
    v_add_f32 v13, v13, v15
    v_add_f32 v12, v12, v16
    v_add_f32 v13, v13, v17
    v_add_f32 v12, v12, v18
    v_add_f32 v13, v13, v19
    v_add_f32 v12, v12, v20
    v_add_f32 v13, v13, v21
    v_add_f32 v12, v12, v22
    v_add_f32 v13, v13, v23
    v_add_f32 v12, v12, v24
    v_add_f32 v13, v13, v25
    v_add_f32 v12, v12, v26
    v_add_f32 v13, v13, v27
    v_mul_f32 v16, 0x3acccccd, v12
    v_mul_f32 v1, 0x3acccccd, v13
    v_fma_f32 v1, -v16, v16, v1
    v_max_f32 v1, 0, v1
    v_cvt_pk_bf16_f32 v16, v16, v16
    v_lshlrev_b32 v16, 16, v16
    v_cvt_pk_bf16_f32 v1, v1, v1
    v_lshlrev_b32 v1, 16, v1
    v_add_f32 v1, 0x3727c5ac, v1
    v_cvt_pk_bf16_f32 v1, v1, v1
    v_lshlrev_b32 v1, 16, v1
    v_sqrt_f32 v1, v1
    s_nop 0
    v_cvt_pk_bf16_f32 v1, v1, v1
    v_lshlrev_b32 v1, 16, v1
    v_rcp_f32 v20, v1
    s_nop 0
    v_sub_f32 v16, 0, v16
    v_mul_f32 v17, 0xc0135761, v20
    v_mul_f32 v21, v20, v20
    v_mul_f32 v18, v21, v20
    v_mul_f32 v18, 0xbdd2d3e8, v18
    v_rcp_f32 v19, v21
    v_lshlrev_b32 v1, 4, v0
    v_add_u32 v1, 159744, v1
    ds_write_b128 v1, v[16:19]
    s_branch k4e_57
k4e_56:
    v_pk_add_f32 v[104:105], v[104:105], v[108:109]
    v_pk_add_f32 v[106:107], v[106:107], v[110:111]
    v_pk_add_f32 v[104:105], v[104:105], v[112:113]
    v_pk_add_f32 v[106:107], v[106:107], v[114:115]
    v_pk_add_f32 v[104:105], v[104:105], v[116:117]
    v_pk_add_f32 v[106:107], v[106:107], v[118:119]
    v_pk_add_f32 v[104:105], v[104:105], v[120:121]
    v_pk_add_f32 v[106:107], v[106:107], v[122:123]
    v_pk_add_f32 v[104:105], v[104:105], v[124:125]
    v_pk_add_f32 v[106:107], v[106:107], v[126:127]
    v_pk_add_f32 v[104:105], v[104:105], v[128:129]
    v_pk_add_f32 v[106:107], v[106:107], v[130:131]
    v_pk_add_f32 v[104:105], v[104:105], v[132:133]
    v_pk_add_f32 v[106:107], v[106:107], v[134:135]
    v_and_b32 v1, 63, v0
    v_min_u32 v1, 23, v1
    v_lshlrev_b32 v1, 4, v1
    s_sub_u32 s71, s67, 6
    s_mul_i32 s71, s71, 384
    s_add_u32 s71, s71, 161792
    v_add_u32 v1, s71, v1
    ds_write_b128 v1, v[104:107]
k4e_57:
    s_waitcnt lgkmcnt(0)
    s_setprio 0
    s_waitcnt vmcnt(1)
    s_barrier
    s_and_b32 s71, s2, 7
    s_lshr_b32 s70, s2, 3
    s_mov_b32 s12, s70
    s_mov_b32 s13, s71
    s_and_b32 s73, s71, 1
    s_mul_i32 s73, s73, 6
    s_and_b32 s72, s70, 1
    s_add_u32 s73, s73, s72
    s_lshr_b32 s72, s71, 1
    s_lshl_b32 s72, s72, 3
    s_and_b32 s68, s70, 7
    s_add_u32 s68, s68, s72
    s_lshl_b32 s68, s68, 6
    s_and_b32 s71, s71, 1
    s_lshl_b32 s71, s71, 2
    s_lshr_b32 s70, s70, 3
    s_add_u32 s70, s70, s71
    s_mul_i32 s69, s70, 160
    s_add_u32 s40, s38, 8392704
    s_addc_u32 s41, s39, 0
    s_mov_b32 s42, 6291456
    s_mov_b32 s43, 0x00020000
    s_add_u32 s44, s38, 14716928
    s_addc_u32 s45, s39, 0
    s_mov_b32 s46, 6717440
    s_mov_b32 s47, 0x00020000
    s_mul_i32 s14, s70, 245760
    s_mov_b32 s48, s34
    s_mov_b32 s49, s35
    s_mov_b32 s50, 2621440
    s_mov_b32 s51, 0x00020000
    s_add_u32 s52, s38, 5640192
    s_addc_u32 s53, s39, 0
    s_mov_b32 s54, 2621440
    s_mov_b32 s55, 0x00020000
    s_and_b32 s64, s67, 3
    s_lshl_b32 s64, s64, 10
    v_lshrrev_b32 v2, 8, v0
    v_and_b32 v3, 255, v0
    v_lshlrev_b32 v2, 4, v2
    v_add_u32 v2, s68, v2
    v_mul_u32_u24 v2, 3072, v2
    v_lshl_add_u32 v7, v3, 4, v2
    v_lshlrev_b32 v8, 4, v0
    s_add_u32 s78, s73, 1
    s_sub_u32 s79, s78, 12
    s_cmp_ge_u32 s78, 12
    s_cselect_b32 s78, s79, s78
    s_mul_i32 s66, s78, 20480
    s_add_u32 s66, s66, s14
    s_add_u32 m0, s64, 61440
    s_add_u32 s79, s66, 819200
    buffer_load_dwordx4 v8, s[44:47], s79 offen lds
    s_add_u32 m0, s64, 65536
    s_add_u32 s79, s66, 823296
    buffer_load_dwordx4 v8, s[44:47], s79 offen lds
    s_add_u32 m0, s64, 69632
    s_add_u32 s79, s66, 827392
    buffer_load_dwordx4 v8, s[44:47], s79 offen lds
    s_add_u32 m0, s64, 73728
    s_add_u32 s79, s66, 831488
    buffer_load_dwordx4 v8, s[44:47], s79 offen lds
    s_add_u32 m0, s64, 77824
    s_add_u32 s79, s66, 835584
    buffer_load_dwordx4 v8, s[44:47], s79 offen lds
    s_barrier
    s_mov_b32 s78, s73
    s_mul_i32 s66, s78, 20480
    s_add_u32 s66, s66, s14
    s_add_u32 m0, s64, 24576
    s_add_u32 s79, s66, 819200
    buffer_load_dwordx4 v8, s[44:47], s79 offen lds
    s_add_u32 m0, s64, 28672
    s_add_u32 s79, s66, 823296
    buffer_load_dwordx4 v8, s[44:47], s79 offen lds
    s_add_u32 m0, s64, 32768
    s_add_u32 s79, s66, 827392
    buffer_load_dwordx4 v8, s[44:47], s79 offen lds
    s_add_u32 m0, s64, 36864
    s_add_u32 s79, s66, 831488
    buffer_load_dwordx4 v8, s[44:47], s79 offen lds
    s_add_u32 m0, s64, 40960
    s_add_u32 s79, s66, 835584
    buffer_load_dwordx4 v8, s[44:47], s79 offen lds
    s_add_u32 s78, s73, 2
    s_sub_u32 s79, s78, 12
    s_cmp_ge_u32 s78, 12
    s_cselect_b32 s78, s79, s78
    s_mul_i32 s66, s78, 20480
    s_add_u32 s66, s66, s14
    s_add_u32 m0, s64, 98304
    s_add_u32 s79, s66, 819200
    buffer_load_dwordx4 v8, s[44:47], s79 offen lds
    s_add_u32 m0, s64, 102400
    s_add_u32 s79, s66, 823296
    buffer_load_dwordx4 v8, s[44:47], s79 offen lds
    s_add_u32 m0, s64, 106496
    s_add_u32 s79, s66, 827392
    buffer_load_dwordx4 v8, s[44:47], s79 offen lds
    s_add_u32 m0, s64, 110592
    s_add_u32 s79, s66, 831488
    buffer_load_dwordx4 v8, s[44:47], s79 offen lds
    s_add_u32 m0, s64, 114688
    s_add_u32 s79, s66, 835584
    buffer_load_dwordx4 v8, s[44:47], s79 offen lds
    s_add_u32 s78, s73, 3
    s_sub_u32 s79, s78, 12
    s_cmp_ge_u32 s78, 12
    s_cselect_b32 s78, s79, s78
    s_mul_i32 s66, s78, 20480
    s_add_u32 s66, s66, s14
    s_add_u32 m0, s64, 135168
    s_add_u32 s79, s66, 819200
    buffer_load_dwordx4 v8, s[44:47], s79 offen lds
    s_add_u32 m0, s64, 139264
    s_add_u32 s79, s66, 823296
    buffer_load_dwordx4 v8, s[44:47], s79 offen lds
    s_add_u32 m0, s64, 143360
    s_add_u32 s79, s66, 827392
    buffer_load_dwordx4 v8, s[44:47], s79 offen lds
    s_add_u32 m0, s64, 147456
    s_add_u32 s79, s66, 831488
    buffer_load_dwordx4 v8, s[44:47], s79 offen lds
    s_add_u32 m0, s64, 151552
    s_add_u32 s79, s66, 835584
    buffer_load_dwordx4 v8, s[44:47], s79 offen lds
    s_barrier
    s_mov_b32 s78, s73
    s_mul_i32 s65, s78, 4096
    s_add_u32 m0, s64, 8192
    s_nop 0
    buffer_load_dwordx4 v7, s[40:43], s65 offen sc1 lds
    s_add_u32 m0, s64, 12288
    s_add_u32 s65, s65, 49152
    buffer_load_dwordx4 v7, s[40:43], s65 offen sc1 lds
    s_add_u32 m0, s64, 16384
    s_add_u32 s65, s65, 49152
    buffer_load_dwordx4 v7, s[40:43], s65 offen sc1 lds
    s_add_u32 m0, s64, 20480
    s_add_u32 s65, s65, 49152
    buffer_load_dwordx4 v7, s[40:43], s65 offen sc1 lds
    s_add_u32 s78, s73, 1
    s_sub_u32 s79, s78, 12
    s_cmp_ge_u32 s78, 12
    s_cselect_b32 s78, s79, s78
    s_mul_i32 s65, s78, 4096
    s_add_u32 m0, s64, 45056
    s_nop 0
    buffer_load_dwordx4 v7, s[40:43], s65 offen sc1 lds
    s_add_u32 m0, s64, 49152
    s_add_u32 s65, s65, 49152
    buffer_load_dwordx4 v7, s[40:43], s65 offen sc1 lds
    s_add_u32 m0, s64, 53248
    s_add_u32 s65, s65, 49152
    buffer_load_dwordx4 v7, s[40:43], s65 offen sc1 lds
    s_add_u32 m0, s64, 57344
    s_add_u32 s65, s65, 49152
    buffer_load_dwordx4 v7, s[40:43], s65 offen sc1 lds
    s_waitcnt vmcnt(4)
    s_barrier
    s_add_u32 s78, s73, 2
    s_sub_u32 s79, s78, 12
    s_cmp_ge_u32 s78, 12
    s_cselect_b32 s78, s79, s78
    s_mul_i32 s65, s78, 4096
    s_add_u32 m0, s64, 81920
    s_nop 0
    buffer_load_dwordx4 v7, s[40:43], s65 offen sc1 lds
    s_add_u32 m0, s64, 86016
    s_add_u32 s65, s65, 49152
    buffer_load_dwordx4 v7, s[40:43], s65 offen sc1 lds
    s_add_u32 m0, s64, 90112
    s_add_u32 s65, s65, 49152
    buffer_load_dwordx4 v7, s[40:43], s65 offen sc1 lds
    s_add_u32 m0, s64, 94208
    s_add_u32 s65, s65, 49152
    buffer_load_dwordx4 v7, s[40:43], s65 offen sc1 lds
    s_add_u32 s78, s73, 3
    s_sub_u32 s79, s78, 12
    s_cmp_ge_u32 s78, 12
    s_cselect_b32 s78, s79, s78
    s_mul_i32 s65, s78, 4096
    s_add_u32 m0, s64, 118784
    s_nop 0
    buffer_load_dwordx4 v7, s[40:43], s65 offen sc1 lds
    s_add_u32 m0, s64, 122880
    s_add_u32 s65, s65, 49152
    buffer_load_dwordx4 v7, s[40:43], s65 offen sc1 lds
    s_add_u32 m0, s64, 126976
    s_add_u32 s65, s65, 49152
    buffer_load_dwordx4 v7, s[40:43], s65 offen sc1 lds
    s_add_u32 m0, s64, 131072
    s_add_u32 s65, s65, 49152
    buffer_load_dwordx4 v7, s[40:43], s65 offen sc1 lds
    s_waitcnt vmcnt(8)
    s_barrier
    s_add_u32 s78, s73, 4
    s_sub_u32 s79, s78, 12
    s_cmp_ge_u32 s78, 12
    s_cselect_b32 s78, s79, s78
    s_mul_i32 s65, s78, 4096
    s_add_u32 m0, s64, 8192
    s_nop 0
    buffer_load_dwordx4 v7, s[40:43], s65 offen sc1 lds
    s_add_u32 m0, s64, 12288
    s_add_u32 s65, s65, 49152
    buffer_load_dwordx4 v7, s[40:43], s65 offen sc1 lds
    s_add_u32 m0, s64, 16384
    s_add_u32 s65, s65, 49152
    buffer_load_dwordx4 v7, s[40:43], s65 offen sc1 lds
    s_add_u32 m0, s64, 20480
    s_add_u32 s65, s65, 49152
    buffer_load_dwordx4 v7, s[40:43], s65 offen sc1 lds
    s_mul_i32 s66, s78, 20480
    s_add_u32 s66, s66, s14
    s_add_u32 m0, s64, 24576
    s_add_u32 s79, s66, 819200
    buffer_load_dwordx4 v8, s[44:47], s79 offen lds
    s_add_u32 m0, s64, 28672
    s_add_u32 s79, s66, 823296
    buffer_load_dwordx4 v8, s[44:47], s79 offen lds
    s_add_u32 m0, s64, 32768
    s_add_u32 s79, s66, 827392
    buffer_load_dwordx4 v8, s[44:47], s79 offen lds
    s_add_u32 m0, s64, 36864
    s_add_u32 s79, s66, 831488
    buffer_load_dwordx4 v8, s[44:47], s79 offen lds
    s_add_u32 m0, s64, 40960
    s_add_u32 s79, s66, 835584
    buffer_load_dwordx4 v8, s[44:47], s79 offen lds
    s_waitcnt vmcnt(13)
    s_barrier
    s_add_u32 s78, s73, 5
    s_sub_u32 s79, s78, 12
    s_cmp_ge_u32 s78, 12
    s_cselect_b32 s78, s79, s78
    s_mul_i32 s65, s78, 4096
    s_add_u32 m0, s64, 45056
    s_nop 0
    buffer_load_dwordx4 v7, s[40:43], s65 offen sc1 lds
    s_add_u32 m0, s64, 49152
    s_add_u32 s65, s65, 49152
    buffer_load_dwordx4 v7, s[40:43], s65 offen sc1 lds
    s_add_u32 m0, s64, 53248
    s_add_u32 s65, s65, 49152
    buffer_load_dwordx4 v7, s[40:43], s65 offen sc1 lds
    s_add_u32 m0, s64, 57344
    s_add_u32 s65, s65, 49152
    buffer_load_dwordx4 v7, s[40:43], s65 offen sc1 lds
    s_mul_i32 s66, s78, 20480
    s_add_u32 s66, s66, s14
    s_add_u32 m0, s64, 61440
    s_add_u32 s79, s66, 819200
    buffer_load_dwordx4 v8, s[44:47], s79 offen lds
    s_add_u32 m0, s64, 65536
    s_add_u32 s79, s66, 823296
    buffer_load_dwordx4 v8, s[44:47], s79 offen lds
    s_add_u32 m0, s64, 69632
    s_add_u32 s79, s66, 827392
    buffer_load_dwordx4 v8, s[44:47], s79 offen lds
    s_add_u32 m0, s64, 73728
    s_add_u32 s79, s66, 831488
    buffer_load_dwordx4 v8, s[44:47], s79 offen lds
    s_add_u32 m0, s64, 77824
    s_add_u32 s79, s66, 835584
    buffer_load_dwordx4 v8, s[44:47], s79 offen lds
    s_waitcnt vmcnt(18)
    s_barrier
    s_add_u32 s78, s73, 6
    s_sub_u32 s79, s78, 12
    s_cmp_ge_u32 s78, 12
    s_cselect_b32 s78, s79, s78
    s_mul_i32 s65, s78, 4096
    s_add_u32 m0, s64, 81920
    s_nop 0
    buffer_load_dwordx4 v7, s[40:43], s65 offen sc1 lds
    s_add_u32 m0, s64, 86016
    s_add_u32 s65, s65, 49152
    buffer_load_dwordx4 v7, s[40:43], s65 offen sc1 lds
    s_add_u32 m0, s64, 90112
    s_add_u32 s65, s65, 49152
    buffer_load_dwordx4 v7, s[40:43], s65 offen sc1 lds
    s_add_u32 m0, s64, 94208
    s_add_u32 s65, s65, 49152
    buffer_load_dwordx4 v7, s[40:43], s65 offen sc1 lds
    s_mul_i32 s66, s78, 20480
    s_add_u32 s66, s66, s14
    s_add_u32 m0, s64, 98304
    s_add_u32 s79, s66, 819200
    buffer_load_dwordx4 v8, s[44:47], s79 offen lds
    s_add_u32 m0, s64, 102400
    s_add_u32 s79, s66, 823296
    buffer_load_dwordx4 v8, s[44:47], s79 offen lds
    s_add_u32 m0, s64, 106496
    s_add_u32 s79, s66, 827392
    buffer_load_dwordx4 v8, s[44:47], s79 offen lds
    s_add_u32 m0, s64, 110592
    s_add_u32 s79, s66, 831488
    buffer_load_dwordx4 v8, s[44:47], s79 offen lds
    s_add_u32 m0, s64, 114688
    s_add_u32 s79, s66, 835584
    buffer_load_dwordx4 v8, s[44:47], s79 offen lds
    s_waitcnt vmcnt(18)
    s_barrier
    s_add_u32 s78, s73, 7
    s_sub_u32 s79, s78, 12
    s_cmp_ge_u32 s78, 12
    s_cselect_b32 s78, s79, s78
    s_mul_i32 s65, s78, 4096
    s_add_u32 m0, s64, 118784
    s_nop 0
    buffer_load_dwordx4 v7, s[40:43], s65 offen sc1 lds
    s_add_u32 m0, s64, 122880
    s_add_u32 s65, s65, 49152
    buffer_load_dwordx4 v7, s[40:43], s65 offen sc1 lds
    s_add_u32 m0, s64, 126976
    s_add_u32 s65, s65, 49152
    buffer_load_dwordx4 v7, s[40:43], s65 offen sc1 lds
    s_add_u32 m0, s64, 131072
    s_add_u32 s65, s65, 49152
    buffer_load_dwordx4 v7, s[40:43], s65 offen sc1 lds
    s_mul_i32 s66, s78, 20480
    s_add_u32 s66, s66, s14
    s_add_u32 m0, s64, 135168
    s_add_u32 s79, s66, 819200
    buffer_load_dwordx4 v8, s[44:47], s79 offen lds
    s_add_u32 m0, s64, 139264
    s_add_u32 s79, s66, 823296
    buffer_load_dwordx4 v8, s[44:47], s79 offen lds
    s_add_u32 m0, s64, 143360
    s_add_u32 s79, s66, 827392
    buffer_load_dwordx4 v8, s[44:47], s79 offen lds
    s_add_u32 m0, s64, 147456
    s_add_u32 s79, s66, 831488
    buffer_load_dwordx4 v8, s[44:47], s79 offen lds
    s_add_u32 m0, s64, 151552
    s_add_u32 s79, s66, 835584
    buffer_load_dwordx4 v8, s[44:47], s79 offen lds
    s_waitcnt vmcnt(18)
    s_barrier
    s_add_u32 s78, s73, 8
    s_sub_u32 s79, s78, 12
    s_cmp_ge_u32 s78, 12
    s_cselect_b32 s78, s79, s78
    s_mul_i32 s65, s78, 4096
    s_add_u32 m0, s64, 8192
    s_nop 0
    buffer_load_dwordx4 v7, s[40:43], s65 offen sc1 lds
    s_add_u32 m0, s64, 12288
    s_add_u32 s65, s65, 49152
    buffer_load_dwordx4 v7, s[40:43], s65 offen sc1 lds
    s_add_u32 m0, s64, 16384
    s_add_u32 s65, s65, 49152
    buffer_load_dwordx4 v7, s[40:43], s65 offen sc1 lds
    s_add_u32 m0, s64, 20480
    s_add_u32 s65, s65, 49152
    buffer_load_dwordx4 v7, s[40:43], s65 offen sc1 lds
    s_mul_i32 s66, s78, 20480
    s_add_u32 s66, s66, s14
    s_add_u32 m0, s64, 24576
    s_add_u32 s79, s66, 819200
    buffer_load_dwordx4 v8, s[44:47], s79 offen lds
    s_add_u32 m0, s64, 28672
    s_add_u32 s79, s66, 823296
    buffer_load_dwordx4 v8, s[44:47], s79 offen lds
    s_add_u32 m0, s64, 32768
    s_add_u32 s79, s66, 827392
    buffer_load_dwordx4 v8, s[44:47], s79 offen lds
    s_add_u32 m0, s64, 36864
    s_add_u32 s79, s66, 831488
    buffer_load_dwordx4 v8, s[44:47], s79 offen lds
    s_add_u32 m0, s64, 40960
    s_add_u32 s79, s66, 835584
    buffer_load_dwordx4 v8, s[44:47], s79 offen lds
    s_waitcnt vmcnt(18)
    s_barrier
    s_add_u32 s78, s73, 9
    s_sub_u32 s79, s78, 12
    s_cmp_ge_u32 s78, 12
    s_cselect_b32 s78, s79, s78
    s_mul_i32 s65, s78, 4096
    s_add_u32 m0, s64, 45056
    s_nop 0
    buffer_load_dwordx4 v7, s[40:43], s65 offen sc1 lds
    s_add_u32 m0, s64, 49152
    s_add_u32 s65, s65, 49152
    buffer_load_dwordx4 v7, s[40:43], s65 offen sc1 lds
    s_add_u32 m0, s64, 53248
    s_add_u32 s65, s65, 49152
    buffer_load_dwordx4 v7, s[40:43], s65 offen sc1 lds
    s_add_u32 m0, s64, 57344
    s_add_u32 s65, s65, 49152
    buffer_load_dwordx4 v7, s[40:43], s65 offen sc1 lds
    s_mul_i32 s66, s78, 20480
    s_add_u32 s66, s66, s14
    s_add_u32 m0, s64, 61440
    s_add_u32 s79, s66, 819200
    buffer_load_dwordx4 v8, s[44:47], s79 offen lds
    s_add_u32 m0, s64, 65536
    s_add_u32 s79, s66, 823296
    buffer_load_dwordx4 v8, s[44:47], s79 offen lds
    s_add_u32 m0, s64, 69632
    s_add_u32 s79, s66, 827392
    buffer_load_dwordx4 v8, s[44:47], s79 offen lds
    s_add_u32 m0, s64, 73728
    s_add_u32 s79, s66, 831488
    buffer_load_dwordx4 v8, s[44:47], s79 offen lds
    s_add_u32 m0, s64, 77824
    s_add_u32 s79, s66, 835584
    buffer_load_dwordx4 v8, s[44:47], s79 offen lds
    s_waitcnt vmcnt(18)
    s_barrier
    s_add_u32 s78, s73, 10
    s_sub_u32 s79, s78, 12
    s_cmp_ge_u32 s78, 12
    s_cselect_b32 s78, s79, s78
    s_mul_i32 s65, s78, 4096
    s_add_u32 m0, s64, 81920
    s_nop 0
    buffer_load_dwordx4 v7, s[40:43], s65 offen sc1 lds
    s_add_u32 m0, s64, 86016
    s_add_u32 s65, s65, 49152
    buffer_load_dwordx4 v7, s[40:43], s65 offen sc1 lds
    s_add_u32 m0, s64, 90112
    s_add_u32 s65, s65, 49152
    buffer_load_dwordx4 v7, s[40:43], s65 offen sc1 lds
    s_add_u32 m0, s64, 94208
    s_add_u32 s65, s65, 49152
    buffer_load_dwordx4 v7, s[40:43], s65 offen sc1 lds
    s_mul_i32 s66, s78, 20480
    s_add_u32 s66, s66, s14
    s_add_u32 m0, s64, 98304
    s_add_u32 s79, s66, 819200
    buffer_load_dwordx4 v8, s[44:47], s79 offen lds
    s_add_u32 m0, s64, 102400
    s_add_u32 s79, s66, 823296
    buffer_load_dwordx4 v8, s[44:47], s79 offen lds
    s_add_u32 m0, s64, 106496
    s_add_u32 s79, s66, 827392
    buffer_load_dwordx4 v8, s[44:47], s79 offen lds
    s_add_u32 m0, s64, 110592
    s_add_u32 s79, s66, 831488
    buffer_load_dwordx4 v8, s[44:47], s79 offen lds
    s_add_u32 m0, s64, 114688
    s_add_u32 s79, s66, 835584
    buffer_load_dwordx4 v8, s[44:47], s79 offen lds
    s_waitcnt vmcnt(18)
    s_barrier
    s_add_u32 s78, s73, 11
    s_sub_u32 s79, s78, 12
    s_cmp_ge_u32 s78, 12
    s_cselect_b32 s78, s79, s78
    s_mul_i32 s65, s78, 4096
    s_add_u32 m0, s64, 118784
    s_nop 0
    buffer_load_dwordx4 v7, s[40:43], s65 offen sc1 lds
    s_add_u32 m0, s64, 122880
    s_add_u32 s65, s65, 49152
    buffer_load_dwordx4 v7, s[40:43], s65 offen sc1 lds
    s_add_u32 m0, s64, 126976
    s_add_u32 s65, s65, 49152
    buffer_load_dwordx4 v7, s[40:43], s65 offen sc1 lds
    s_add_u32 m0, s64, 131072
    s_add_u32 s65, s65, 49152
    buffer_load_dwordx4 v7, s[40:43], s65 offen sc1 lds
    s_mul_i32 s66, s78, 20480
    s_add_u32 s66, s66, s14
    s_add_u32 m0, s64, 135168
    s_add_u32 s79, s66, 819200
    buffer_load_dwordx4 v8, s[44:47], s79 offen lds
    s_add_u32 m0, s64, 139264
    s_add_u32 s79, s66, 823296
    buffer_load_dwordx4 v8, s[44:47], s79 offen lds
    s_add_u32 m0, s64, 143360
    s_add_u32 s79, s66, 827392
    buffer_load_dwordx4 v8, s[44:47], s79 offen lds
    s_add_u32 m0, s64, 147456
    s_add_u32 s79, s66, 831488
    buffer_load_dwordx4 v8, s[44:47], s79 offen lds
    s_add_u32 m0, s64, 151552
    s_add_u32 s79, s66, 835584
    buffer_load_dwordx4 v8, s[44:47], s79 offen lds
    s_waitcnt vmcnt(18)
    s_barrier
    s_waitcnt vmcnt(9)
    s_barrier
    s_waitcnt vmcnt(0)
    s_barrier
    s_barrier
    s_endpgm
k2_code_end:
.section .rodata,"a"
.p2align 6
.amdhsa_kernel k2_attn_kernel
  .amdhsa_next_free_vgpr 256
  .amdhsa_next_free_sgpr 102
  .amdhsa_accum_offset 256
  .amdhsa_group_segment_fixed_size 0
  .amdhsa_kernarg_size 96
  .amdhsa_user_sgpr_count 2
  .amdhsa_user_sgpr_kernarg_segment_ptr 1
  .amdhsa_system_sgpr_workgroup_id_x 1
.end_amdhsa_kernel
```
